```python
import torch

def _softmax(x, axis=-1):
    return torch.softmax(x, dim=axis)
def _gelu(x):
    return torch.nn.functional.gelu(x, approximate="tanh")
def _silu(x):
    return torch.nn.functional.silu(x)
def _sigmoid(x):
    return torch.sigmoid(x)
def _layernorm(x, axis=-1, eps=1e-5):
    m = x.mean(dim=axis, keepdim=True)
    v = x.var(dim=axis, keepdim=True, unbiased=False)
    return (x - m) / torch.sqrt(v + eps)
def _scatter_add(tgt, idx, src, axis=0):
    return tgt.clone().index_add_(axis, idx, src)
def _segment_sum(src, seg, n):
    out = torch.zeros((n,) + src.shape[1:], dtype=src.dtype)
    return out.index_add_(0, seg, src)
def _pad(x, pw):
    flat = tuple(v for pair in reversed(pw) for v in pair)
    return torch.nn.functional.pad(x, flat)

kernel_name = 'parallel_sum__compressed_kv_cla__glu_gated_bilinear__decode'

def setup_inputs():

    _w = (lambda a: (lambda t: t.to(torch.bfloat16) if t.is_floating_point() else t)(torch.as_tensor(a)))
    def _A_setup():
        B, H, Sq, Sk, D, M = 2, 32, 1, 8192, 128, 512
        Dc = 4 * D
        return {
            "x": _w((lambda *s: torch.randn(*s, dtype=torch.bfloat16) * 0.05)(B, Sq, M)),
            "c_kv": _w((lambda *s: torch.randn(*s, dtype=torch.bfloat16) * 0.8)(B, Sk, Dc)),
            "w_q": _w((lambda *s: torch.randn(*s, dtype=torch.bfloat16) * 1.6)(M, H, D) * (M ** -0.5)),
            "w_uk": _w((lambda *s: torch.randn(*s, dtype=torch.bfloat16) * 1.6)(Dc, H, D) * (Dc ** -0.5)),
            "w_uv": _w((lambda *s: torch.randn(*s, dtype=torch.bfloat16) * 0.8)(Dc, H, D) * (Dc ** -0.5)),
            "w_o": _w((lambda *s: torch.randn(*s, dtype=torch.bfloat16) * 0.8)(H, D, M) * ((H * D) ** -0.5)),
        }
    _A_in = _A_setup()

    def _B_setup():
        B, S, D, F = 2, 1, 512, 1792
        return {
            "x": _w((lambda *s: torch.randn(*s, dtype=torch.bfloat16) * 0.05)(B, S, D)),
            "w_gate": _w((lambda *s: torch.randn(*s, dtype=torch.bfloat16) * 0.4)(D, F) * (D ** -0.5)),
            "w_up": _w((lambda *s: torch.randn(*s, dtype=torch.bfloat16) * 0.4)(D, F) * (D ** -0.5)),
            "w_down": _w((lambda *s: torch.randn(*s, dtype=torch.bfloat16) * 0.4)(F, D) * (F ** -0.5)),
        }
    _B_in = _B_setup()

    return {
        "A_x": _A_in["x"],
        "A_c_kv": _A_in["c_kv"],
        "A_w_q": _A_in["w_q"],
        "A_w_uk": _A_in["w_uk"],
        "A_w_uv": _A_in["w_uv"],
        "A_w_o": _A_in["w_o"],
        "B_x": _B_in["x"],
        "B_w_gate": _B_in["w_gate"],
        "B_w_up": _B_in["w_up"],
        "B_w_down": _B_in["w_down"],
    }

def reference(A_x, A_c_kv, A_w_q, A_w_uk, A_w_uv, A_w_o, B_x, B_w_gate, B_w_up, B_w_down):
    def _A_ref(x, c_kv, w_q, w_uk, w_uv, w_o):
        B, Sq, M = x.shape[0], x.shape[1], x.shape[2]
        Sk = c_kv.shape[1]
        H, D = w_q.shape[1], w_q.shape[2]
        q = torch.einsum("bqm,mhd->bhqd", x, w_q)
        k = torch.einsum("bkc,chd->bhkd", c_kv, w_uk)
        v = torch.einsum("bkc,chd->bhkd", c_kv, w_uv)
        scores = torch.einsum("bhqd,bhkd->bhqk", q, k) * (D ** -0.5)
        off = Sk - Sq
        qi = torch.arange(Sq)[:, None]
        kj = torch.arange(Sk)[None, :]
        cmask = kj <= (qi + off)
        scores = torch.where(cmask[None, None], scores, -1e9)
        p = _softmax(scores, axis=-1)
        ctx = torch.einsum("bhqk,bhkd->bhqd", p, v)
        return torch.einsum("bhqd,hdm->bqm", ctx, w_o)

    def _B_ref(x, w_gate, w_up, w_down):
        g = torch.einsum("bsd,df->bsf", x, w_gate)
        u = torch.einsum("bsd,df->bsf", x, w_up)
        h = g * u
        return torch.einsum("bsf,fd->bsd", h, w_down)

    x = A_x
    xn = _layernorm(x, axis=-1)
    return x + _A_ref(xn, A_c_kv, A_w_q, A_w_uk, A_w_uv, A_w_o) + _B_ref(xn, B_w_gate, B_w_up, B_w_down)
```

```asm
; @launch grid=(256,1,1) block=(512,1,1) lds=163840
.amdgcn_target "amdgcn-amd-amdhsa--gfx950"
.text
.globl parallel_sum__compressed_kv_cla__glu_gated_bilinear__decode_kernel
.p2align 8
.type parallel_sum__compressed_kv_cla__glu_gated_bilinear__decode_kernel,@function
parallel_sum__compressed_kv_cla__glu_gated_bilinear__decode_kernel:
    s_cmp_ge_u32 s2, 256
    s_cbranch_scc1 L_end
    s_load_dwordx16 s[4:19], s[0:1], 0
    s_load_dwordx8 s[20:27], s[0:1], 64
    s_load_dwordx2 s[28:29], s[0:1], 96
    v_lshrrev_b32 v1, 6, v0
    v_and_b32 v0, 63, v0
    s_and_b32 s30, s2, 7
    v_readfirstlane_b32 s32, v1
    s_lshr_b32 s31, s2, 3
    v_mov_b32 v25, 154944
    v_and_b32 v2, 15, v0
    v_mov_b32 v27, 0
    v_and_b32 v28, 31, v0
    v_lshl_add_u32 v28, v28, 2, v25
    ds_write_b32 v28, v27
    s_lshr_b32 s66, s31, 1
    s_lshl_b32 s33, s30, 4
    s_add_u32 s33, s33, s66
    s_lshr_b32 s34, s33, 2
    s_lshr_b32 s37, s30, 2
    s_and_b32 s39, s31, 1
    s_and_b32 s78, s66, 3
    s_and_b32 s79, s32, 3
    s_cmp_lt_u32 s66, 14
    s_cselect_b32 s65, s39, 0
    v_lshrrev_b32 v3, 4, v0
    v_lshlrev_b32 v1, 4, v0
    v_mov_b32 v26, 1
    s_lshr_b32 s68, s32, 1
    s_lshl_b32 s69, s39, 1
    s_add_u32 s68, s68, s69
    s_cmp_eq_u32 s68, 2
    s_cbranch_scc1 L_ln
    s_cmp_ge_u32 s32, 4
    s_cbranch_scc1 L_tail0
    s_cmp_eq_u32 s39, 1
    s_cbranch_scc1 L_headL0
    v_lshrrev_b32 v4, 1, v3
    v_lshlrev_b32 v4, 5, v4
    v_and_b32 v5, 1, v3
    v_add_u32 v4, v4, v5
    s_lshl_b32 s68, s32, 7
    v_add_u32 v4, s68, v4
    v_lshlrev_b32 v4, 13, v4
    v_lshl_add_u32 v4, v2, 4, v4
    s_lshl_b32 s69, s34, 8
    v_add_u32 v4, s69, v4
    v_add_u32 v5, 0x80000, v4
    s_lshl_b32 s70, s78, 16
    s_mov_b32 s46, 4194304
    s_mov_b32 s47, 0x20000
    s_waitcnt lgkmcnt(0)
    s_mov_b32 s44, s8
    s_mov_b32 s45, s9
    s_barrier
    buffer_load_dwordx4 v[32:35], v4, s[44:47], s70 offen
    buffer_load_dwordx4 v[36:39], v5, s[44:47], s70 offen
    s_add_u32 s70, s70, 0x4000
    s_and_b32 s70, s70, 0x3ffff
    buffer_load_dwordx4 v[40:43], v4, s[44:47], s70 offen
    buffer_load_dwordx4 v[44:47], v5, s[44:47], s70 offen
    s_add_u32 s70, s70, 0x4000
    s_and_b32 s70, s70, 0x3ffff
    buffer_load_dwordx4 v[48:51], v4, s[44:47], s70 offen
    buffer_load_dwordx4 v[52:55], v5, s[44:47], s70 offen
    s_add_u32 s70, s70, 0x4000
    s_and_b32 s70, s70, 0x3ffff
    buffer_load_dwordx4 v[56:59], v4, s[44:47], s70 offen
    buffer_load_dwordx4 v[60:63], v5, s[44:47], s70 offen
    s_add_u32 s70, s70, 0x4000
    s_and_b32 s70, s70, 0x3ffff
    buffer_load_dwordx4 v[64:67], v4, s[44:47], s70 offen
    buffer_load_dwordx4 v[68:71], v5, s[44:47], s70 offen
    s_add_u32 s70, s70, 0x4000
    s_and_b32 s70, s70, 0x3ffff
    s_load_dword s36, s[28:29], 0
    s_setprio 1
    s_mov_b32 s40, s28
    s_mov_b32 s41, s29
    s_mov_b32 s42, 268435456
    s_mov_b32 s43, 0x20000
    v_and_b32 v27, 4, v0
    v_cmp_eq_u32 vcc, 0, v27
    v_mov_b32 v28, 0xffff
    v_mov_b32 v29, 0xffff0000
    v_cndmask_b32 v20, 0, v28, vcc
    v_cndmask_b32 v22, 0, v29, vcc
    v_xor_b32 v21, v20, v28
    v_xor_b32 v23, v22, v29
    v_and_b32 v27, 3, v0
    v_mul_u32_u24 v24, 0x5555, v27
    v_bfe_u32 v7, v0, 3, 1
    v_lshlrev_b32 v7, 10, v7
    v_lshl_add_u32 v7, v3, 6, v7
    s_lshl_b32 s68, s32, 8
    s_add_u32 s68, s68, 147456
    v_add_u32 v7, s68, v7
    s_add_u32 s68, s78, 0
    s_and_b32 s68, s68, 3
    s_lshl_b32 s68, s68, 4
    v_add_u32 v8, s68, v7
    s_add_u32 s68, s78, 1
    s_and_b32 s68, s68, 3
    s_lshl_b32 s68, s68, 4
    v_add_u32 v9, s68, v7
    s_add_u32 s68, s78, 2
    s_and_b32 s68, s68, 3
    s_lshl_b32 s68, s68, 4
    v_add_u32 v10, s68, v7
    s_add_u32 s68, s78, 3
    s_and_b32 s68, s68, 3
    s_lshl_b32 s68, s68, 4
    v_add_u32 v11, s68, v7
    v_mov_b32 v184, 0
    v_mov_b32 v185, 0
    v_mov_b32 v186, 0
    v_mov_b32 v187, 0
    s_lshl_b32 s68, s32, 10
    s_add_u32 s68, s68, 149504
    v_add_u32 v7, s68, v1
    v_add_u32 v200, 149504, v1
    s_cmp_eq_u32 s32, 0
    s_cselect_b32 s75, 0x4000, 0
    s_add_u32 s75, s75, 114688
    s_lshl_b32 s72, s32, 9
    s_add_u32 s72, s72, 153600
    v_and_b32 v12, 7, v0
    v_lshlrev_b32 v12, 1, v12
    v_bfe_u32 v13, v0, 3, 1
    v_add_u32 v12, v12, v13
    v_lshlrev_b32 v12, 10, v12
    v_xor_b32 v13, v3, v2
    v_lshl_add_u32 v12, v13, 4, v12
    v_add_u32 v201, s75, v12
    v_xor_b32 v202, 64, v201
    v_xor_b32 v203, 128, v201
    v_xor_b32 v204, 192, v201
    v_mov_b32 v208, 0
    v_mov_b32 v209, 0
    v_mov_b32 v210, 0
    v_mov_b32 v211, 0
    v_mov_b32 v212, 0
    v_mov_b32 v213, 0
    v_mov_b32 v214, 0
    v_mov_b32 v215, 0
    v_mov_b32 v216, 0
    v_mov_b32 v217, 0
    v_mov_b32 v218, 0
    v_mov_b32 v219, 0
    v_mov_b32 v220, 0
    v_mov_b32 v221, 0
    v_mov_b32 v222, 0
    v_mov_b32 v223, 0
    v_lshrrev_b32 v12, 1, v3
    v_lshlrev_b32 v12, 8, v12
    v_lshl_add_u32 v12, v2, 3, v12
    v_and_b32 v13, 1, v3
    v_lshl_add_u32 v12, v13, 2, v12
    v_add_u32 v205, s72, v12
    v_bfe_u32 v13, v0, 2, 1
    v_lshlrev_b32 v13, 8, v13
    v_and_b32 v12, 1, v0
    v_lshl_add_u32 v13, v12, 7, v13
    v_lshl_add_u32 v13, v3, 4, v13
    v_add_u32 v206, s72, v13
    v_mul_u32_u24 v14, 0xaaaa, v12
    v_add_u32 v14, 0x4444, v14
    v_lshlrev_b32 v207, 15, v3
    v_lshl_add_u32 v207, v2, 4, v207
    v_mov_b32 v15, 0xfffefffe
    s_lshl_b32 s64, s34, 10
    s_lshl_b32 s69, s78, 8
    s_add_u32 s64, s64, s69
    s_lshl_b32 s69, s32, 7
    s_add_u32 s64, s64, s69
    s_add_u32 s64, s64, 4096
L_w1:
    ds_read_b32 v27, v25 offset:16
    ds_read_b128 v[160:163], v8
    ds_read_b128 v[164:167], v9
    ds_read_b128 v[168:171], v10
    ds_read_b128 v[172:175], v11
    s_waitcnt lgkmcnt(0)
    v_readfirstlane_b32 s68, v27
    s_nop 0
    s_cmp_lt_u32 s68, 2
    s_cbranch_scc1 L_w1
    s_add_u32 s36, s36, 1
    s_and_b32 s68, s36, 0xff
    v_and_b32 v27, 7, v0
    v_xor_b32 v27, s68, v27
    v_bfe_u32 v28, v27, 0, 1
    v_bfe_u32 v29, v27, 1, 1
    v_lshl_or_b32 v16, v29, 16, v28
    v_bfe_u32 v28, v27, 2, 1
    v_bfe_u32 v29, v27, 3, 1
    v_lshl_or_b32 v17, v29, 16, v28
    v_bfe_u32 v28, v27, 4, 1
    v_bfe_u32 v29, v27, 5, 1
    v_lshl_or_b32 v18, v29, 16, v28
    v_bfe_u32 v28, v27, 6, 1
    v_bfe_u32 v29, v27, 7, 1
    v_lshl_or_b32 v19, v29, 16, v28
    v_and_b32 v176, v160, v20
    v_and_b32 v177, v160, v21
    v_and_b32 v178, v160, v22
    v_and_b32 v179, v160, v23
    buffer_load_dwordx4 v[72:75], v4, s[44:47], s70 offen
    buffer_load_dwordx4 v[76:79], v5, s[44:47], s70 offen
    s_add_u32 s70, s70, 0x4000
    s_and_b32 s70, s70, 0x3ffff
    v_and_b32 v180, v161, v20
    v_and_b32 v181, v161, v21
    v_and_b32 v182, v161, v22
    v_and_b32 v183, v161, v23
    s_waitcnt vmcnt(10)
    v_smfmac_f32_16x16x64_bf16 v[184:187], v[176:179], v[32:39], v24
    buffer_load_dwordx4 v[80:83], v4, s[44:47], s70 offen
    buffer_load_dwordx4 v[84:87], v5, s[44:47], s70 offen
    s_add_u32 s70, s70, 0x4000
    s_and_b32 s70, s70, 0x3ffff
    v_and_b32 v176, v162, v20
    v_and_b32 v177, v162, v21
    v_and_b32 v178, v162, v22
    v_and_b32 v179, v162, v23
    s_waitcnt vmcnt(10)
    v_smfmac_f32_16x16x64_bf16 v[184:187], v[180:183], v[40:47], v24
    buffer_load_dwordx4 v[88:91], v4, s[44:47], s70 offen
    buffer_load_dwordx4 v[92:95], v5, s[44:47], s70 offen
    s_add_u32 s70, s70, 0x4000
    s_and_b32 s70, s70, 0x3ffff
    v_and_b32 v180, v163, v20
    v_and_b32 v181, v163, v21
    v_and_b32 v182, v163, v22
    v_and_b32 v183, v163, v23
    s_waitcnt vmcnt(10)
    v_smfmac_f32_16x16x64_bf16 v[184:187], v[176:179], v[48:55], v24
    buffer_load_dwordx4 v[96:99], v4, s[44:47], s70 offen
    buffer_load_dwordx4 v[100:103], v5, s[44:47], s70 offen
    s_add_u32 s70, s70, 0x4000
    s_and_b32 s70, s70, 0x3ffff
    v_and_b32 v176, v164, v20
    v_and_b32 v177, v164, v21
    v_and_b32 v178, v164, v22
    v_and_b32 v179, v164, v23
    s_waitcnt vmcnt(10)
    v_smfmac_f32_16x16x64_bf16 v[184:187], v[180:183], v[56:63], v24
    buffer_load_dwordx4 v[104:107], v4, s[44:47], s70 offen
    buffer_load_dwordx4 v[108:111], v5, s[44:47], s70 offen
    s_add_u32 s70, s70, 0x4000
    s_and_b32 s70, s70, 0x3ffff
    v_and_b32 v180, v165, v20
    v_and_b32 v181, v165, v21
    v_and_b32 v182, v165, v22
    v_and_b32 v183, v165, v23
    s_waitcnt vmcnt(10)
    v_smfmac_f32_16x16x64_bf16 v[184:187], v[176:179], v[64:71], v24
    buffer_load_dwordx4 v[112:115], v4, s[44:47], s70 offen
    buffer_load_dwordx4 v[116:119], v5, s[44:47], s70 offen
    s_add_u32 s70, s70, 0x4000
    s_and_b32 s70, s70, 0x3ffff
    v_and_b32 v176, v166, v20
    v_and_b32 v177, v166, v21
    v_and_b32 v178, v166, v22
    v_and_b32 v179, v166, v23
    s_waitcnt vmcnt(10)
    v_smfmac_f32_16x16x64_bf16 v[184:187], v[180:183], v[72:79], v24
    buffer_load_dwordx4 v[120:123], v4, s[44:47], s70 offen
    buffer_load_dwordx4 v[124:127], v5, s[44:47], s70 offen
    s_add_u32 s70, s70, 0x4000
    s_and_b32 s70, s70, 0x3ffff
    v_and_b32 v180, v167, v20
    v_and_b32 v181, v167, v21
    v_and_b32 v182, v167, v22
    v_and_b32 v183, v167, v23
    s_waitcnt vmcnt(10)
    v_smfmac_f32_16x16x64_bf16 v[184:187], v[176:179], v[80:87], v24
    buffer_load_dwordx4 v[128:131], v4, s[44:47], s70 offen
    buffer_load_dwordx4 v[132:135], v5, s[44:47], s70 offen
    s_add_u32 s70, s70, 0x4000
    s_and_b32 s70, s70, 0x3ffff
    v_and_b32 v176, v168, v20
    v_and_b32 v177, v168, v21
    v_and_b32 v178, v168, v22
    v_and_b32 v179, v168, v23
    s_waitcnt vmcnt(10)
    v_smfmac_f32_16x16x64_bf16 v[184:187], v[180:183], v[88:95], v24
    buffer_load_dwordx4 v[136:139], v4, s[44:47], s70 offen
    buffer_load_dwordx4 v[140:143], v5, s[44:47], s70 offen
    s_add_u32 s70, s70, 0x4000
    s_and_b32 s70, s70, 0x3ffff
    v_and_b32 v180, v169, v20
    v_and_b32 v181, v169, v21
    v_and_b32 v182, v169, v22
    v_and_b32 v183, v169, v23
    s_waitcnt vmcnt(10)
    v_smfmac_f32_16x16x64_bf16 v[184:187], v[176:179], v[96:103], v24
    buffer_load_dwordx4 v[144:147], v4, s[44:47], s70 offen
    buffer_load_dwordx4 v[148:151], v5, s[44:47], s70 offen
    s_add_u32 s70, s70, 0x4000
    s_and_b32 s70, s70, 0x3ffff
    v_and_b32 v176, v170, v20
    v_and_b32 v177, v170, v21
    v_and_b32 v178, v170, v22
    v_and_b32 v179, v170, v23
    s_waitcnt vmcnt(10)
    v_smfmac_f32_16x16x64_bf16 v[184:187], v[180:183], v[104:111], v24
    buffer_load_dwordx4 v[152:155], v4, s[44:47], s70 offen
    buffer_load_dwordx4 v[156:159], v5, s[44:47], s70 offen
    s_mov_b64 exec, 1
    ds_add_u32 v25, v26 offset:20
    s_mov_b64 exec, -1
    v_and_b32 v180, v171, v20
    v_and_b32 v181, v171, v21
    v_and_b32 v182, v171, v22
    v_and_b32 v183, v171, v23
    s_waitcnt vmcnt(10)
    v_smfmac_f32_16x16x64_bf16 v[184:187], v[176:179], v[112:119], v24
    v_and_b32 v176, v172, v20
    v_and_b32 v177, v172, v21
    v_and_b32 v178, v172, v22
    v_and_b32 v179, v172, v23
    s_waitcnt vmcnt(8)
    v_smfmac_f32_16x16x64_bf16 v[184:187], v[180:183], v[120:127], v24
    v_and_b32 v180, v173, v20
    v_and_b32 v181, v173, v21
    v_and_b32 v182, v173, v22
    v_and_b32 v183, v173, v23
    s_waitcnt vmcnt(6)
    v_smfmac_f32_16x16x64_bf16 v[184:187], v[176:179], v[128:135], v24
    v_and_b32 v176, v174, v20
    v_and_b32 v177, v174, v21
    v_and_b32 v178, v174, v22
    v_and_b32 v179, v174, v23
    s_waitcnt vmcnt(4)
    v_smfmac_f32_16x16x64_bf16 v[184:187], v[180:183], v[136:143], v24
    v_and_b32 v180, v175, v20
    v_and_b32 v181, v175, v21
    v_and_b32 v182, v175, v22
    v_and_b32 v183, v175, v23
    s_waitcnt vmcnt(2)
    v_smfmac_f32_16x16x64_bf16 v[184:187], v[176:179], v[144:151], v24
    s_waitcnt vmcnt(0)
    v_smfmac_f32_16x16x64_bf16 v[184:187], v[180:183], v[152:159], v24
    s_mov_b32 s69, 1040356334
    s_mov_b32 s70, 0x07060302
    s_nop 5
    ds_write_b128 v7, v[184:187]
    s_mov_b64 exec, 1
    ds_add_u32 v25, v26 offset:0
    s_mov_b64 exec, -1
    s_cmp_ge_u32 s32, 2
    s_cbranch_scc1 L_s2pre
L_w2:
    ds_read_b32 v27, v25 offset:0
    ds_read_b128 v[96:99], v200 offset:0
    ds_read_b128 v[100:103], v200 offset:1024
    ds_read_b128 v[104:107], v200 offset:2048
    ds_read_b128 v[108:111], v200 offset:3072
    s_waitcnt lgkmcnt(0)
    v_readfirstlane_b32 s68, v27
    s_nop 0
    s_cmp_lt_u32 s68, 4
    s_cbranch_scc1 L_w2
    v_add_f32 v96, v96, v100
    v_add_f32 v104, v104, v108
    v_add_f32 v97, v97, v101
    v_add_f32 v105, v105, v109
    v_add_f32 v98, v98, v102
    v_add_f32 v106, v106, v110
    v_add_f32 v99, v99, v103
    v_add_f32 v107, v107, v111
    v_add_f32 v96, v96, v104
    v_add_f32 v97, v97, v105
    v_add_f32 v98, v98, v106
    v_add_f32 v99, v99, v107
    v_cvt_pk_bf16_f32 v96, v96, v97
    v_cvt_pk_bf16_f32 v97, v98, v99
    ds_write2_b32 v205, v96, v97 offset0:0 offset1:32
L_w3:
    ds_read_b32 v27, v25 offset:8
    ds_read_b128 v[112:115], v206
    ds_read_b128 v[116:119], v206 offset:64
    ds_read_b128 v[32:35], v201 offset:0
    ds_read_b128 v[48:51], v201 offset:256
    ds_read_b128 v[64:67], v201 offset:512
    ds_read_b128 v[80:83], v201 offset:768
    ds_read_b128 v[36:39], v202 offset:0
    ds_read_b128 v[52:55], v202 offset:256
    ds_read_b128 v[68:71], v202 offset:512
    ds_read_b128 v[84:87], v202 offset:768
    s_waitcnt lgkmcnt(0)
    v_readfirstlane_b32 s68, v27
    s_nop 0
    s_cmp_lt_u32 s68, 4
    s_cbranch_scc1 L_w3
    ds_read_b128 v[40:43], v203 offset:0
    ds_read_b128 v[56:59], v203 offset:256
    ds_read_b128 v[72:75], v203 offset:512
    ds_read_b128 v[88:91], v203 offset:768
    ds_read_b128 v[44:47], v204 offset:0
    ds_read_b128 v[60:63], v204 offset:256
    ds_read_b128 v[76:79], v204 offset:512
    ds_read_b128 v[92:95], v204 offset:768
    v_smfmac_f32_16x16x64_bf16 v[208:211], v[112:115], v[32:39], v14
    v_smfmac_f32_16x16x64_bf16 v[212:215], v[112:115], v[48:55], v14
    v_smfmac_f32_16x16x64_bf16 v[216:219], v[112:115], v[64:71], v14
    v_smfmac_f32_16x16x64_bf16 v[220:223], v[112:115], v[80:87], v14
    s_waitcnt lgkmcnt(0)
    v_smfmac_f32_16x16x64_bf16 v[208:211], v[116:119], v[40:47], v14
    v_smfmac_f32_16x16x64_bf16 v[212:215], v[116:119], v[56:63], v14
    v_smfmac_f32_16x16x64_bf16 v[216:219], v[116:119], v[72:79], v14
    v_smfmac_f32_16x16x64_bf16 v[220:223], v[116:119], v[88:95], v14
    s_mov_b64 exec, 1
    ds_add_u32 v25, v26 offset:4
    s_mov_b64 exec, -1
    s_nop 1
    v_add_f32 v208, v208, v209
    v_add_f32 v212, v212, v213
    v_add_f32 v216, v216, v217
    v_add_f32 v220, v220, v221
    v_mul_f32 v208, s69, v208
    v_mul_f32 v212, s69, v212
    v_mul_f32 v216, s69, v216
    v_mul_f32 v220, s69, v220
    v_perm_b32 v96, v212, v208, s70
    v_perm_b32 v97, v220, v216, s70
    v_add_u32 v96, 0x10001, v96
    v_add_u32 v97, 0x10001, v97
    s_nop 0
    v_mov_b32_dpp v98, v96 row_ror:8 row_mask:0xf bank_mask:0xf
    v_mov_b32_dpp v99, v97 row_ror:8 row_mask:0xf bank_mask:0xf
    v_and_or_b32 v96, v96, v15, v16
    v_and_or_b32 v97, v97, v15, v17
    v_and_or_b32 v98, v98, v15, v18
    v_and_or_b32 v99, v99, v15, v19
    s_mov_b64 exec, 0x00ff00ff
    buffer_store_dwordx4 v[96:99], v207, s[40:43], s64 offen sc1
    s_mov_b64 exec, -1
    s_mov_b64 exec, 1
    ds_add_u32 v25, v26 offset:36
    s_mov_b64 exec, -1
    s_branch L_s2pre
L_headL0:
    s_lshl_b32 s69, s34, 8
    v_lshrrev_b32 v4, 2, v0
    v_lshlrev_b32 v4, 5, v4
    v_and_b32 v5, 3, v0
    v_add_u32 v4, v4, v5
    v_lshlrev_b32 v4, 13, v4
    v_lshlrev_b32 v5, 13, v0
    s_lshl_b32 s70, s78, 16
    s_add_u32 s70, s70, s69
    s_add_u32 s70, s70, 0x8000
    s_lshl_b32 s71, s78, 20
    s_add_u32 s71, s71, s69
    s_add_u32 s72, s71, 0x80000
    s_waitcnt lgkmcnt(0)
    s_barrier
    s_cmp_lg_u32 s32, 2
    s_cbranch_scc1 L_headL1
    s_mov_b32 s44, s8
    s_mov_b32 s45, s9
    s_mov_b32 s46, 4194304
    s_mov_b32 s47, 0x20000
    buffer_load_dword v224, v4, s[44:47], s70 offen
    buffer_load_dword v225, v4, s[44:47], s70 offen offset:128
    s_mov_b32 s48, s10
    s_mov_b32 s49, s11
    s_mov_b32 s50, 4194304
    s_mov_b32 s51, 0x20000
    buffer_load_dword v226, v5, s[48:51], s71 offen
    buffer_load_dword v227, v5, s[48:51], s71 offen offset:128
    buffer_load_dword v228, v5, s[48:51], s72 offen
    buffer_load_dword v229, v5, s[48:51], s72 offen offset:128
L_headL1:
    s_load_dword s36, s[28:29], 0
    s_setprio 1
    s_mov_b32 s40, s28
    s_mov_b32 s41, s29
    s_mov_b32 s42, 268435456
    s_mov_b32 s43, 0x20000
    v_and_b32 v27, 4, v0
    v_cmp_eq_u32 vcc, 0, v27
    v_mov_b32 v28, 0xffff
    v_mov_b32 v29, 0xffff0000
    v_cndmask_b32 v20, 0, v28, vcc
    v_cndmask_b32 v22, 0, v29, vcc
    v_xor_b32 v21, v20, v28
    v_xor_b32 v23, v22, v29
    v_and_b32 v27, 3, v0
    v_mul_u32_u24 v24, 0x5555, v27
    s_waitcnt lgkmcnt(0)
    s_add_u32 s36, s36, 1
    s_and_b32 s68, s36, 0xff
    v_and_b32 v27, 7, v0
    v_xor_b32 v27, s68, v27
    v_bfe_u32 v28, v27, 0, 1
    v_bfe_u32 v29, v27, 1, 1
    v_lshl_or_b32 v16, v29, 16, v28
    v_bfe_u32 v28, v27, 2, 1
    v_bfe_u32 v29, v27, 3, 1
    v_lshl_or_b32 v17, v29, 16, v28
    v_bfe_u32 v28, v27, 4, 1
    v_bfe_u32 v29, v27, 5, 1
    v_lshl_or_b32 v18, v29, 16, v28
    v_bfe_u32 v28, v27, 6, 1
    v_bfe_u32 v29, v27, 7, 1
    v_lshl_or_b32 v19, v29, 16, v28
    s_mov_b64 exec, 1
    ds_add_u32 v25, v26 offset:4
    s_mov_b64 exec, -1
L_s2pre:
    s_lshl_b32 s75, s37, 1
    s_add_u32 s75, s75, s39
    s_lshl_b32 s75, s75, 14
    s_lshl_b32 s68, s32, 12
    s_add_u32 s75, s75, s68
    s_add_u32 s75, s75, 4096
    s_lshl_b32 s68, s32, 2
    s_add_u32 s68, s68, 0
    s_and_b32 s69, s68, 7
    s_lshl_b32 s69, s69, 1
    s_lshr_b32 s70, s68, 3
    s_or_b32 s69, s69, s70
    s_lshl_b32 s69, s69, 4
    s_lshl_b32 s68, s68, 10
    s_add_u32 s68, s68, 131072
    v_xor_b32 v8, s69, v1
    v_add_u32 v8, s68, v8
    s_lshl_b32 s68, s32, 2
    s_add_u32 s68, s68, 1
    s_and_b32 s69, s68, 7
    s_lshl_b32 s69, s69, 1
    s_lshr_b32 s70, s68, 3
    s_or_b32 s69, s69, s70
    s_lshl_b32 s69, s69, 4
    s_lshl_b32 s68, s68, 10
    s_add_u32 s68, s68, 131072
    v_xor_b32 v9, s69, v1
    v_add_u32 v9, s68, v9
    s_lshl_b32 s68, s32, 2
    s_add_u32 s68, s68, 2
    s_and_b32 s69, s68, 7
    s_lshl_b32 s69, s69, 1
    s_lshr_b32 s70, s68, 3
    s_or_b32 s69, s69, s70
    s_lshl_b32 s69, s69, 4
    s_lshl_b32 s68, s68, 10
    s_add_u32 s68, s68, 131072
    v_xor_b32 v10, s69, v1
    v_add_u32 v10, s68, v10
    s_lshl_b32 s68, s32, 2
    s_add_u32 s68, s68, 3
    s_and_b32 s69, s68, 7
    s_lshl_b32 s69, s69, 1
    s_lshr_b32 s70, s68, 3
    s_or_b32 s69, s69, s70
    s_lshl_b32 s69, s69, 4
    s_lshl_b32 s68, s68, 10
    s_add_u32 s68, s68, 131072
    v_xor_b32 v11, s69, v1
    v_add_u32 v11, s68, v11
    v_and_b32 v12, 7, v2
    v_lshlrev_b32 v12, 1, v12
    v_lshrrev_b32 v13, 3, v2
    v_or_b32 v12, v12, v13
    v_lshlrev_b32 v13, 1, v3
    v_xor_b32 v12, v12, v13
    v_lshlrev_b32 v12, 4, v12
    v_lshl_add_u32 v12, v2, 10, v12
    s_lshl_b32 s68, s32, 14
    v_xor_b32 v13, 0, v12
    v_add_u32 v232, 131072, v13
    v_add_u32 v236, s68, v13
    v_xor_b32 v13, 16, v12
    v_add_u32 v233, 131072, v13
    v_add_u32 v237, s68, v13
    v_xor_b32 v13, 128, v12
    v_add_u32 v234, 131072, v13
    v_add_u32 v238, s68, v13
    v_xor_b32 v13, 144, v12
    v_add_u32 v235, 131072, v13
    v_add_u32 v239, s68, v13
    v_lshlrev_b32 v4, 4, v2
    s_lshl_b32 s68, s32, 2
    v_add_u32 v4, 154624, v4
    v_add_u32 v5, s68, v4
    s_lshr_b32 s68, s32, 1
    s_lshl_b32 s68, s68, 10
    s_and_b32 s69, s32, 1
    s_lshl_b32 s69, s69, 3
    s_add_u32 s68, s68, s69
    s_add_u32 s68, s68, 149504
    v_add_u32 v6, s68, v1
    v_lshlrev_b32 v7, 6, v2
    v_lshl_add_u32 v7, v3, 2, v7
    s_lshl_b32 s68, s32, 4
    s_add_u32 s68, s68, 155264
    v_add_u32 v7, s68, v7
    s_mov_b32 s48, s14
    s_mov_b32 s49, s15
    s_mov_b32 s50, 4194304
    s_mov_b32 s51, 0x20000
    v_lshlrev_b32 v14, 10, v3
    v_lshl_add_u32 v14, v2, 4, v14
    s_lshl_b32 s68, s32, 8
    v_add_u32 v30, s68, v14
    v_add_u32 v31, 0x1000, v30
    s_lshl_b32 s73, s34, 17
    s_lshl_b32 s74, s78, 15
    s_mov_b32 s76, 0
    s_mov_b32 s69, 0x10001
L_w4:
    ds_read_b32 v27, v25 offset:4
    s_waitcnt lgkmcnt(0)
    v_readfirstlane_b32 s68, v27
    s_nop 0
    s_cmp_lt_u32 s68, 2
    s_cbranch_scc1 L_w4
L_w5:
    ds_read_b32 v27, v25 offset:24
    s_waitcnt lgkmcnt(0)
    v_readfirstlane_b32 s68, v27
    s_nop 0
    s_cmp_lt_u32 s68, 4
    s_cbranch_scc1 L_w5
    buffer_load_dwordx4 v[160:163], v1, s[40:43], s75 offen offset:0 sc1
    buffer_load_dwordx4 v[164:167], v1, s[40:43], s75 offen offset:1024 sc1
    buffer_load_dwordx4 v[168:171], v1, s[40:43], s75 offen offset:2048 sc1
    buffer_load_dwordx4 v[172:175], v1, s[40:43], s75 offen offset:3072 sc1
    s_mov_b64 exec, 1
    ds_add_u32 v25, v26 offset:44
    s_mov_b64 exec, -1
L_w6:
    ds_read_b32 v27, v25 offset:12
    s_waitcnt lgkmcnt(0)
    v_readfirstlane_b32 s68, v27
    s_nop 0
    s_cmp_lt_u32 s68, 4
    s_cbranch_scc1 L_w6
    ds_read_b128 v[32:35], v236 offset:0
    ds_read_b128 v[36:39], v237 offset:0
    ds_read_b128 v[40:43], v238 offset:0
    ds_read_b128 v[44:47], v239 offset:0
    ds_read_b128 v[48:51], v236 offset:256
    ds_read_b128 v[52:55], v237 offset:256
    ds_read_b128 v[56:59], v238 offset:256
    ds_read_b128 v[60:63], v239 offset:256
    ds_read_b128 v[64:67], v236 offset:512
    ds_read_b128 v[68:71], v237 offset:512
    ds_read_b128 v[72:75], v238 offset:512
    ds_read_b128 v[76:79], v239 offset:512
    ds_read_b128 v[80:83], v236 offset:768
    ds_read_b128 v[84:87], v237 offset:768
    ds_read_b128 v[88:91], v238 offset:768
    ds_read_b128 v[92:95], v239 offset:768
    v_add_u32 v236, 0x10000, v236
    v_add_u32 v237, 0x10000, v237
    v_add_u32 v238, 0x10000, v238
    v_add_u32 v239, 0x10000, v239
    s_waitcnt vmcnt(0)
L_s2loop:
    s_add_u32 s76, s76, 1
    v_xor_b32 v160, v160, v16
    v_xor_b32 v161, v161, v17
    v_xor_b32 v162, v162, v18
    v_xor_b32 v163, v163, v19
    ds_write_b128 v8, v[160:163]
    v_xor_b32 v164, v164, v16
    v_xor_b32 v165, v165, v17
    v_xor_b32 v166, v166, v18
    v_xor_b32 v167, v167, v19
    ds_write_b128 v9, v[164:167]
    v_xor_b32 v168, v168, v16
    v_xor_b32 v169, v169, v17
    v_xor_b32 v170, v170, v18
    v_xor_b32 v171, v171, v19
    ds_write_b128 v10, v[168:171]
    v_xor_b32 v172, v172, v16
    v_xor_b32 v173, v173, v17
    v_xor_b32 v174, v174, v18
    v_xor_b32 v175, v175, v19
    ds_write_b128 v11, v[172:175]
    v_or3_b32 v28, v160, v161, v162
    v_or3_b32 v28, v28, v163, v164
    v_or3_b32 v28, v28, v165, v166
    v_or3_b32 v28, v28, v167, v168
    v_or3_b32 v28, v28, v169, v170
    v_or3_b32 v28, v28, v171, v172
    v_or3_b32 v28, v28, v173, v174
    v_or_b32 v28, v28, v175
    v_and_b32 v28, s69, v28
    v_cmp_ne_u32 vcc, 0, v28
    s_cmp_gt_u32 s76, 200000
    s_cbranch_scc1 L_s2out
    s_cbranch_vccz L_s2out
    s_waitcnt lgkmcnt(0)
    buffer_load_dwordx4 v[160:163], v1, s[40:43], s75 offen offset:0 sc1
    buffer_load_dwordx4 v[164:167], v1, s[40:43], s75 offen offset:1024 sc1
    buffer_load_dwordx4 v[168:171], v1, s[40:43], s75 offen offset:2048 sc1
    buffer_load_dwordx4 v[172:175], v1, s[40:43], s75 offen offset:3072 sc1
    s_waitcnt vmcnt(0)
    s_branch L_s2loop
L_s2out:
    s_cmp_eq_u32 s39, 1
    s_cbranch_scc1 L_nopre
    s_add_u32 s70, s74, 0
    s_and_b32 s70, s70, 0x1ffff
    s_add_u32 s70, s70, s73
    buffer_load_dwordx4 v[240:243], v30, s[48:51], s70 offen
    buffer_load_dwordx4 v[244:247], v31, s[48:51], s70 offen
    s_add_u32 s70, s74, 8192
    s_and_b32 s70, s70, 0x1ffff
    s_add_u32 s70, s70, s73
    buffer_load_dwordx4 v[248:251], v30, s[48:51], s70 offen
    buffer_load_dwordx4 v[252:255], v31, s[48:51], s70 offen
L_nopre:
    s_waitcnt lgkmcnt(0)
    s_barrier
    ds_read_b128 v[160:163], v232 offset:0
    ds_read_b128 v[164:167], v233 offset:0
    ds_read_b128 v[168:171], v234 offset:0
    ds_read_b128 v[172:175], v235 offset:0
    ds_read_b128 v[176:179], v232 offset:256
    ds_read_b128 v[180:183], v233 offset:256
    ds_read_b128 v[184:187], v234 offset:256
    ds_read_b128 v[188:191], v235 offset:256
    ds_read_b128 v[192:195], v232 offset:512
    ds_read_b128 v[196:199], v233 offset:512
    ds_read_b128 v[200:203], v234 offset:512
    ds_read_b128 v[204:207], v235 offset:512
    s_cmp_eq_u32 s39, 1
    ds_read_b128 v[208:211], v232 offset:768
    s_waitcnt lgkmcnt(12)
    v_mfma_f32_16x16x32_bf16 v[224:227], v[32:35], v[160:163], 0
    ds_read_b128 v[212:215], v233 offset:768
    s_waitcnt lgkmcnt(12)
    v_mfma_f32_16x16x32_bf16 v[224:227], v[36:39], v[164:167], v[224:227]
    ds_read_b128 v[216:219], v234 offset:768
    s_waitcnt lgkmcnt(12)
    v_mfma_f32_16x16x32_bf16 v[224:227], v[40:43], v[168:171], v[224:227]
    ds_read_b128 v[220:223], v235 offset:768
    s_waitcnt lgkmcnt(12)
    v_mfma_f32_16x16x32_bf16 v[224:227], v[44:47], v[172:175], v[224:227]
    ds_read_b128 v[96:99], v236 offset:0
    s_waitcnt lgkmcnt(12)
    v_mfma_f32_16x16x32_bf16 v[224:227], v[48:51], v[176:179], v[224:227]
    ds_read_b128 v[100:103], v237 offset:0
    s_waitcnt lgkmcnt(12)
    v_mfma_f32_16x16x32_bf16 v[224:227], v[52:55], v[180:183], v[224:227]
    ds_read_b128 v[104:107], v238 offset:0
    s_waitcnt lgkmcnt(12)
    v_mfma_f32_16x16x32_bf16 v[224:227], v[56:59], v[184:187], v[224:227]
    ds_read_b128 v[108:111], v239 offset:0
    s_waitcnt lgkmcnt(12)
    v_mfma_f32_16x16x32_bf16 v[224:227], v[60:63], v[188:191], v[224:227]
    ds_read_b128 v[112:115], v236 offset:256
    s_waitcnt lgkmcnt(12)
    v_mfma_f32_16x16x32_bf16 v[224:227], v[64:67], v[192:195], v[224:227]
    ds_read_b128 v[116:119], v237 offset:256
    s_waitcnt lgkmcnt(12)
    v_mfma_f32_16x16x32_bf16 v[224:227], v[68:71], v[196:199], v[224:227]
    ds_read_b128 v[120:123], v238 offset:256
    s_waitcnt lgkmcnt(12)
    v_mfma_f32_16x16x32_bf16 v[224:227], v[72:75], v[200:203], v[224:227]
    ds_read_b128 v[124:127], v239 offset:256
    s_waitcnt lgkmcnt(12)
    v_mfma_f32_16x16x32_bf16 v[224:227], v[76:79], v[204:207], v[224:227]
    ds_read_b128 v[128:131], v236 offset:512
    s_waitcnt lgkmcnt(12)
    v_mfma_f32_16x16x32_bf16 v[224:227], v[80:83], v[208:211], v[224:227]
    ds_read_b128 v[132:135], v237 offset:512
    s_waitcnt lgkmcnt(12)
    v_mfma_f32_16x16x32_bf16 v[224:227], v[84:87], v[212:215], v[224:227]
    ds_read_b128 v[136:139], v238 offset:512
    s_waitcnt lgkmcnt(12)
    v_mfma_f32_16x16x32_bf16 v[224:227], v[88:91], v[216:219], v[224:227]
    ds_read_b128 v[140:143], v239 offset:512
    s_waitcnt lgkmcnt(12)
    v_mfma_f32_16x16x32_bf16 v[224:227], v[92:95], v[220:223], v[224:227]
    ds_read_b128 v[144:147], v236 offset:768
    s_waitcnt lgkmcnt(12)
    v_mfma_f32_16x16x32_bf16 v[228:231], v[96:99], v[160:163], 0
    ds_read_b128 v[148:151], v237 offset:768
    s_waitcnt lgkmcnt(12)
    v_mfma_f32_16x16x32_bf16 v[228:231], v[100:103], v[164:167], v[228:231]
    ds_read_b128 v[152:155], v238 offset:768
    s_waitcnt lgkmcnt(12)
    v_mfma_f32_16x16x32_bf16 v[228:231], v[104:107], v[168:171], v[228:231]
    ds_read_b128 v[156:159], v239 offset:768
    s_barrier
    s_waitcnt lgkmcnt(12)
    v_mfma_f32_16x16x32_bf16 v[228:231], v[108:111], v[172:175], v[228:231]
    s_waitcnt lgkmcnt(11)
    v_mfma_f32_16x16x32_bf16 v[228:231], v[112:115], v[176:179], v[228:231]
    s_waitcnt lgkmcnt(10)
    v_mfma_f32_16x16x32_bf16 v[228:231], v[116:119], v[180:183], v[228:231]
    s_waitcnt lgkmcnt(9)
    v_mfma_f32_16x16x32_bf16 v[228:231], v[120:123], v[184:187], v[228:231]
    s_waitcnt lgkmcnt(8)
    v_mfma_f32_16x16x32_bf16 v[228:231], v[124:127], v[188:191], v[228:231]
    s_waitcnt lgkmcnt(7)
    v_mfma_f32_16x16x32_bf16 v[228:231], v[128:131], v[192:195], v[228:231]
    s_waitcnt lgkmcnt(6)
    v_mfma_f32_16x16x32_bf16 v[228:231], v[132:135], v[196:199], v[228:231]
    s_waitcnt lgkmcnt(5)
    v_mfma_f32_16x16x32_bf16 v[228:231], v[136:139], v[200:203], v[228:231]
    s_waitcnt lgkmcnt(4)
    v_mfma_f32_16x16x32_bf16 v[228:231], v[140:143], v[204:207], v[228:231]
    s_waitcnt lgkmcnt(3)
    v_mfma_f32_16x16x32_bf16 v[228:231], v[144:147], v[208:211], v[228:231]
    s_waitcnt lgkmcnt(2)
    v_mfma_f32_16x16x32_bf16 v[228:231], v[148:151], v[212:215], v[228:231]
    s_waitcnt lgkmcnt(1)
    v_mfma_f32_16x16x32_bf16 v[228:231], v[152:155], v[216:219], v[228:231]
    s_waitcnt lgkmcnt(0)
    v_mfma_f32_16x16x32_bf16 v[228:231], v[156:159], v[220:223], v[228:231]
    s_and_b32 s68, s36, 0xff
    s_xor_b32 s69, s68, 0
    v_mov_b32 v16, s69
    s_xor_b32 s69, s68, 85
    v_mov_b32 v17, s69
    s_xor_b32 s69, s68, 170
    v_mov_b32 v18, s69
    s_xor_b32 s69, s68, 255
    v_mov_b32 v19, s69
    v_max3_f32 v12, v224, v225, v226
    v_max3_f32 v13, v228, v229, v230
    v_max3_f32 v12, v12, v227, v231
    v_max_f32 v12, v12, v13
    v_mov_b32 v13, v12
    s_nop 1
    v_permlane32_swap_b32 v12, v13
    v_max_f32 v12, v12, v13
    v_mov_b32 v13, v12
    s_nop 1
    v_permlane16_swap_b32 v12, v13
    v_max_f32 v12, v12, v13
    ds_write_b32 v5, v12
    s_waitcnt lgkmcnt(0)
    s_barrier
    ds_read_b128 v[208:211], v4
    s_waitcnt lgkmcnt(0)
    v_max3_f32 v12, v208, v209, v210
    v_max_f32 v12, v12, v211
    v_sub_f32 v224, v224, v12
    v_sub_f32 v225, v225, v12
    v_sub_f32 v226, v226, v12
    v_sub_f32 v227, v227, v12
    v_sub_f32 v228, v228, v12
    v_sub_f32 v229, v229, v12
    v_sub_f32 v230, v230, v12
    v_sub_f32 v231, v231, v12
    v_exp_f32 v224, v224
    v_exp_f32 v225, v225
    v_exp_f32 v226, v226
    v_exp_f32 v227, v227
    v_exp_f32 v228, v228
    v_cvt_pk_bf16_f32 v208, v224, v225
    v_exp_f32 v229, v229
    v_cvt_pk_bf16_f32 v209, v226, v227
    v_exp_f32 v230, v230
    ds_write_b64 v6, v[208:209]
    v_exp_f32 v231, v231
    v_add_f32 v13, v224, v225
    v_cvt_pk_bf16_f32 v210, v228, v229
    v_cvt_pk_bf16_f32 v211, v230, v231
    ds_write_b64 v6, v[210:211] offset:2048
    v_add_f32 v14, v226, v227
    v_add_f32 v15, v228, v229
    v_add_f32 v28, v230, v231
    v_add_f32 v13, v13, v14
    v_add_f32 v15, v15, v28
    v_add_f32 v13, v13, v15
    ds_write_b32 v7, v13
    s_waitcnt lgkmcnt(0)
    s_barrier
    s_cmp_lg_u32 s32, 0
    s_cbranch_scc1 L_nostat
    v_lshlrev_b32 v8, 6, v2
    v_add_u32 v8, 155264, v8
    ds_read_b128 v[160:163], v8 offset:0
    ds_read_b128 v[164:167], v8 offset:16
    ds_read_b128 v[168:171], v8 offset:32
    ds_read_b128 v[172:175], v8 offset:48
    s_lshl_b32 s71, s33, 4
    s_lshl_b32 s70, s39, 15
    s_add_u32 s71, s71, s70
    s_add_u32 s71, s71, 393216
    v_lshlrev_b32 v9, 11, v2
    v_mov_b32 v14, s36
    v_not_b32 v15, s36
    s_waitcnt lgkmcnt(0)
    v_add_f32 v160, v160, v168
    v_add_f32 v161, v161, v169
    v_add_f32 v162, v162, v170
    v_add_f32 v163, v163, v171
    v_add_f32 v164, v164, v172
    v_add_f32 v165, v165, v173
    v_add_f32 v166, v166, v174
    v_add_f32 v167, v167, v175
    v_add_f32 v160, v160, v164
    v_add_f32 v161, v161, v165
    v_add_f32 v162, v162, v166
    v_add_f32 v163, v163, v167
    v_add_f32 v160, v160, v161
    v_add_f32 v162, v162, v163
    v_add_f32 v13, v160, v162
    s_mov_b64 exec, 0xffff
    buffer_store_dwordx4 v[12:15], v9, s[40:43], s71 offen sc1
    s_mov_b64 exec, -1
L_nostat:
    v_bfe_u32 v4, v0, 2, 1
    v_bfe_u32 v5, v0, 3, 1
    v_lshl_add_u32 v4, v4, 1, v5
    v_mul_u32_u24 v4, 1472, v4
    v_lshl_add_u32 v4, v3, 4, v4
    v_add_u32 v7, 156288, v4
    v_mov_b32 v9, 0xffffff00
    s_lshl_b32 s71, s39, 7
    s_add_u32 s71, s71, s33
    s_lshl_b32 s71, s71, 12
    s_lshl_b32 s69, s32, 10
    s_add_u32 s71, s71, s69
    s_add_u32 s71, s71, 1048576
    s_mov_b32 s77, 0
    v_mov_b32 v232, 0
    v_mov_b32 v233, 0
    v_mov_b32 v234, 0
    v_mov_b32 v235, 0
    s_cmp_eq_u32 s39, 1
    s_cbranch_scc1 L_hL
    s_mov_b32 s60, s4
    s_mov_b32 s61, s5
    s_mov_b32 s62, 2048
    s_mov_b32 s63, 0x20000
    s_bfe_u32 s68, s33, 0x10004
    s_lshl_b32 s68, s68, 9
    s_lshr_b32 s69, s33, 5
    s_lshl_b32 s69, s69, 7
    s_add_u32 s68, s68, s69
    s_and_b32 s69, s33, 7
    s_lshl_b32 s69, s69, 4
    s_add_u32 s68, s68, s69
    s_bfe_u32 s69, s33, 0x10003
    s_lshl_b32 s69, s69, 2
    s_add_u32 s68, s68, s69
    s_lshl_b32 s64, s68, 1
    v_and_b32 v4, 1, v3
    v_lshlrev_b32 v4, 1, v4
    v_lshrrev_b32 v5, 1, v3
    v_or_b32 v4, v4, v5
    v_and_b32 v5, 1, v0
    v_lshl_add_u32 v4, v5, 3, v4
    v_lshlrev_b32 v6, 1, v4
    v_lshlrev_b32 v11, 5, v3
    v_lshl_add_u32 v11, v5, 4, v11
    v_add_u32 v11, 155072, v11
    s_lshl_b32 s69, s32, 2
    v_add_u32 v10, s69, v11
    v_lshrrev_b32 v8, 1, v0
    v_lshlrev_b32 v8, 12, v8
    v_lshl_add_u32 v8, v5, 4, v8
    s_lshl_b32 s72, s33, 5
    s_lshl_b32 s69, s32, 17
    s_add_u32 s72, s72, s69
    s_add_u32 s72, s72, 1048576
    s_add_u32 s75, s72, 0x80000
L_w7:
    ds_read_b32 v27, v25 offset:28
    s_waitcnt lgkmcnt(0)
    v_readfirstlane_b32 s68, v27
    s_nop 0
    s_cmp_lt_u32 s68, 4
    s_cbranch_scc1 L_w7
    buffer_load_ushort v29, v6, s[60:63], s64 offen
    s_add_u32 s70, s74, 16384
    s_and_b32 s70, s70, 0x1ffff
    s_add_u32 s70, s70, s73
    buffer_load_dwordx4 v[32:35], v30, s[48:51], s70 offen
    buffer_load_dwordx4 v[36:39], v31, s[48:51], s70 offen
    s_add_u32 s70, s74, 24576
    s_and_b32 s70, s70, 0x1ffff
    s_add_u32 s70, s70, s73
    buffer_load_dwordx4 v[40:43], v30, s[48:51], s70 offen
    buffer_load_dwordx4 v[44:47], v31, s[48:51], s70 offen
    s_add_u32 s70, s74, 32768
    s_and_b32 s70, s70, 0x1ffff
    s_add_u32 s70, s70, s73
    buffer_load_dwordx4 v[48:51], v30, s[48:51], s70 offen
    buffer_load_dwordx4 v[52:55], v31, s[48:51], s70 offen
    s_add_u32 s70, s74, 40960
    s_and_b32 s70, s70, 0x1ffff
    s_add_u32 s70, s70, s73
    buffer_load_dwordx4 v[56:59], v30, s[48:51], s70 offen
    buffer_load_dwordx4 v[60:63], v31, s[48:51], s70 offen
    s_add_u32 s70, s74, 49152
    s_and_b32 s70, s70, 0x1ffff
    s_add_u32 s70, s70, s73
    buffer_load_dwordx4 v[64:67], v30, s[48:51], s70 offen
    buffer_load_dwordx4 v[68:71], v31, s[48:51], s70 offen
    s_add_u32 s70, s74, 57344
    s_and_b32 s70, s70, 0x1ffff
    s_add_u32 s70, s70, s73
    buffer_load_dwordx4 v[72:75], v30, s[48:51], s70 offen
    buffer_load_dwordx4 v[76:79], v31, s[48:51], s70 offen
    s_mov_b64 exec, 1
    ds_add_u32 v25, v26 offset:32
    s_mov_b64 exec, -1
L_w8:
    ds_read_b32 v27, v25 offset:56
    s_waitcnt lgkmcnt(0)
    v_readfirstlane_b32 s68, v27
    s_nop 0
    s_cmp_lt_u32 s68, 4
    s_cbranch_scc1 L_w8
    s_add_u32 s70, s74, 65536
    s_and_b32 s70, s70, 0x1ffff
    s_add_u32 s70, s70, s73
    buffer_load_dwordx4 v[80:83], v30, s[48:51], s70 offen
    buffer_load_dwordx4 v[84:87], v31, s[48:51], s70 offen
    s_add_u32 s70, s74, 73728
    s_and_b32 s70, s70, 0x1ffff
    s_add_u32 s70, s70, s73
    buffer_load_dwordx4 v[88:91], v30, s[48:51], s70 offen
    buffer_load_dwordx4 v[92:95], v31, s[48:51], s70 offen
    s_add_u32 s70, s74, 81920
    s_and_b32 s70, s70, 0x1ffff
    s_add_u32 s70, s70, s73
    buffer_load_dwordx4 v[96:99], v30, s[48:51], s70 offen
    buffer_load_dwordx4 v[100:103], v31, s[48:51], s70 offen
    s_add_u32 s70, s74, 90112
    s_and_b32 s70, s70, 0x1ffff
    s_add_u32 s70, s70, s73
    buffer_load_dwordx4 v[104:107], v30, s[48:51], s70 offen
    buffer_load_dwordx4 v[108:111], v31, s[48:51], s70 offen
    s_add_u32 s70, s74, 98304
    s_and_b32 s70, s70, 0x1ffff
    s_add_u32 s70, s70, s73
    buffer_load_dwordx4 v[112:115], v30, s[48:51], s70 offen
    buffer_load_dwordx4 v[116:119], v31, s[48:51], s70 offen
    s_add_u32 s70, s74, 106496
    s_and_b32 s70, s70, 0x1ffff
    s_add_u32 s70, s70, s73
    buffer_load_dwordx4 v[120:123], v30, s[48:51], s70 offen
    buffer_load_dwordx4 v[124:127], v31, s[48:51], s70 offen
    s_add_u32 s70, s74, 114688
    s_and_b32 s70, s70, 0x1ffff
    s_add_u32 s70, s70, s73
    buffer_load_dwordx4 v[128:131], v30, s[48:51], s70 offen
    buffer_load_dwordx4 v[132:135], v31, s[48:51], s70 offen
    s_add_u32 s70, s74, 122880
    s_and_b32 s70, s70, 0x1ffff
    s_add_u32 s70, s70, s73
    buffer_load_dwordx4 v[136:139], v30, s[48:51], s70 offen
    buffer_load_dwordx4 v[140:143], v31, s[48:51], s70 offen
    s_mov_b32 s60, s24
    s_mov_b32 s61, s25
    s_mov_b32 s62, 2048
    s_mov_b32 s63, 0x20000
    s_barrier
    ds_read_b128 v[160:163], v7 offset:0
    ds_read_b128 v[164:167], v7 offset:80
    ds_read_b128 v[168:171], v7 offset:160
    ds_read_b128 v[172:175], v7 offset:240
    ds_read_b128 v[176:179], v7 offset:320
    ds_read_b128 v[180:183], v7 offset:400
    ds_read_b128 v[184:187], v7 offset:480
    ds_read_b128 v[188:191], v7 offset:560
    ds_read_b128 v[192:195], v7 offset:640
    ds_read_b128 v[196:199], v7 offset:720
    ds_read_b128 v[200:203], v7 offset:800
    ds_read_b128 v[204:207], v7 offset:880
    ds_read_b128 v[208:211], v7 offset:960
    ds_read_b128 v[212:215], v7 offset:1040
    ds_read_b128 v[216:219], v7 offset:1120
    ds_read_b128 v[220:223], v7 offset:1200
    s_waitcnt vmcnt(30) lgkmcnt(15)
    v_smfmac_f32_16x16x64_bf16 v[232:235], v[160:163], v[240:247], v24
    s_waitcnt vmcnt(28) lgkmcnt(14)
    v_smfmac_f32_16x16x64_bf16 v[232:235], v[164:167], v[248:255], v24
    s_waitcnt vmcnt(26) lgkmcnt(13)
    v_smfmac_f32_16x16x64_bf16 v[232:235], v[168:171], v[32:39], v24
    s_waitcnt vmcnt(24) lgkmcnt(12)
    v_smfmac_f32_16x16x64_bf16 v[232:235], v[172:175], v[40:47], v24
    s_waitcnt vmcnt(22) lgkmcnt(11)
    v_smfmac_f32_16x16x64_bf16 v[232:235], v[176:179], v[48:55], v24
    s_waitcnt vmcnt(20) lgkmcnt(10)
    v_smfmac_f32_16x16x64_bf16 v[232:235], v[180:183], v[56:63], v24
    s_waitcnt vmcnt(18) lgkmcnt(9)
    v_smfmac_f32_16x16x64_bf16 v[232:235], v[184:187], v[64:71], v24
    s_waitcnt vmcnt(16) lgkmcnt(8)
    v_smfmac_f32_16x16x64_bf16 v[232:235], v[188:191], v[72:79], v24
    s_waitcnt vmcnt(14) lgkmcnt(7)
    v_smfmac_f32_16x16x64_bf16 v[232:235], v[192:195], v[80:87], v24
    s_waitcnt vmcnt(12) lgkmcnt(6)
    v_smfmac_f32_16x16x64_bf16 v[232:235], v[196:199], v[88:95], v24
    s_waitcnt vmcnt(10) lgkmcnt(5)
    v_smfmac_f32_16x16x64_bf16 v[232:235], v[200:203], v[96:103], v24
    s_waitcnt vmcnt(8) lgkmcnt(4)
    v_smfmac_f32_16x16x64_bf16 v[232:235], v[204:207], v[104:111], v24
    s_waitcnt vmcnt(6) lgkmcnt(3)
    v_smfmac_f32_16x16x64_bf16 v[232:235], v[208:211], v[112:119], v24
    s_waitcnt vmcnt(4) lgkmcnt(2)
    v_smfmac_f32_16x16x64_bf16 v[232:235], v[212:215], v[120:127], v24
    s_waitcnt vmcnt(2) lgkmcnt(1)
    v_smfmac_f32_16x16x64_bf16 v[232:235], v[216:219], v[128:135], v24
    s_waitcnt vmcnt(0) lgkmcnt(0)
    v_smfmac_f32_16x16x64_bf16 v[232:235], v[220:223], v[136:143], v24
    s_nop 7
    v_and_or_b32 v232, v232, v9, v16
    v_and_or_b32 v233, v233, v9, v17
    v_and_or_b32 v234, v234, v9, v18
    v_and_or_b32 v235, v235, v9, v19
    buffer_store_dwordx4 v[232:235], v1, s[40:43], s71 offen sc1
    s_waitcnt vmcnt(0)
L_s5loop:
    buffer_load_dwordx4 v[32:35], v8, s[40:43], s72 offen sc1
    buffer_load_dwordx4 v[36:39], v8, s[40:43], s75 offen sc1
    s_add_u32 s77, s77, 1
    s_waitcnt vmcnt(0)
    v_xor_b32 v32, v32, v16
    v_xor_b32 v33, v33, v17
    v_xor_b32 v34, v34, v18
    v_xor_b32 v35, v35, v19
    v_xor_b32 v36, v36, v16
    v_xor_b32 v37, v37, v17
    v_xor_b32 v38, v38, v18
    v_xor_b32 v39, v39, v19
    v_or3_b32 v28, v32, v33, v34
    v_or3_b32 v28, v28, v35, v36
    v_or3_b32 v28, v28, v37, v38
    v_or_b32 v28, v28, v39
    v_and_b32 v28, 0xff, v28
    v_cmp_ne_u32 vcc, 0, v28
    s_cmp_gt_u32 s77, 200000
    s_cbranch_scc1 L_s5out
    s_cbranch_vccz L_s5out
    s_mov_b64 exec, vcc
    s_branch L_s5loop
L_s5out:
    s_mov_b64 exec, -1
    v_add_f32 v32, v32, v36
    v_add_f32 v33, v33, v37
    v_add_f32 v34, v34, v38
    v_add_f32 v35, v35, v39
    v_permlane32_swap_b32 v32, v33
    s_nop 0
    v_permlane32_swap_b32 v34, v35
    v_add_f32 v32, v32, v33
    v_add_f32 v34, v34, v35
    s_nop 1
    v_permlane16_swap_b32 v32, v34
    v_add_f32 v32, v32, v34
    s_nop 1
    v_add_f32_dpp v32, v32, v32 row_ror:8 row_mask:0xf bank_mask:0xf
    s_nop 1
    v_add_f32_dpp v32, v32, v32 row_ror:4 row_mask:0xf bank_mask:0xf
    s_nop 1
    v_add_f32_dpp v32, v32, v32 row_ror:2 row_mask:0xf bank_mask:0xf
    ds_write_b32 v10, v32
    s_waitcnt lgkmcnt(0)
    s_barrier
    s_cmp_lg_u32 s32, 0
    s_cbranch_scc1 L_hend
    ds_read_b128 v[32:35], v11
    v_lshlrev_b32 v29, 16, v29
    s_mov_b32 s68, 0x00030003
    s_mov_b32 s69, s68
    s_waitcnt lgkmcnt(0)
    v_add_f32 v32, v32, v33
    v_add_f32 v34, v34, v35
    v_add_f32 v32, v32, v29
    v_add_f32 v32, v32, v34
    v_cvt_pk_bf16_f32 v32, v32, v32
    s_mov_b64 exec, s[68:69]
    buffer_store_short v32, v6, s[60:63], s64 offen
    s_mov_b64 exec, 1
    s_cmp_lg_u32 s2, 0
    s_cbranch_scc1 L_noep
    v_mov_b32 v8, 0
    v_mov_b32 v9, s36
    buffer_store_dword v9, v8, s[40:43], 0 offen
L_noep:
    s_mov_b64 exec, -1
    s_branch L_hend
L_hL:
    s_mov_b32 s52, s22
    s_mov_b32 s53, s23
    s_mov_b32 s54, 1835008
    s_mov_b32 s55, 0x20000
    s_lshl_b32 s70, s66, 17
    s_lshl_b32 s69, s30, 14
    s_add_u32 s70, s70, s69
    s_add_u32 s72, s70, 0x2000
L_w9:
    ds_read_b32 v27, v25 offset:52
    s_waitcnt lgkmcnt(0)
    v_readfirstlane_b32 s68, v27
    s_nop 0
    s_cmp_lt_u32 s68, 4
    s_cbranch_scc1 L_w9
    buffer_load_dwordx4 v[32:35], v30, s[52:55], s70 offen
    buffer_load_dwordx4 v[36:39], v31, s[52:55], s70 offen
    buffer_load_dwordx4 v[40:43], v30, s[52:55], s72 offen
    buffer_load_dwordx4 v[44:47], v31, s[52:55], s72 offen
    s_mov_b64 exec, 1
    ds_add_u32 v25, v26 offset:32
    s_mov_b64 exec, -1
    s_barrier
    s_cmp_eq_u32 s65, 0
    s_cbranch_scc1 L_nodown
    ds_read_b128 v[160:163], v7 offset:1280
    ds_read_b128 v[164:167], v7 offset:1360
    s_waitcnt vmcnt(0) lgkmcnt(0)
    v_smfmac_f32_16x16x64_bf16 v[232:235], v[160:163], v[32:39], v24
    v_smfmac_f32_16x16x64_bf16 v[232:235], v[164:167], v[40:47], v24
    s_nop 7
L_nodown:
    v_and_or_b32 v232, v232, v9, v16
    v_and_or_b32 v233, v233, v9, v17
    v_and_or_b32 v234, v234, v9, v18
    v_and_or_b32 v235, v235, v9, v19
    buffer_store_dwordx4 v[232:235], v1, s[40:43], s71 offen sc1
L_hend:
    s_endpgm
L_ln:
    s_and_b32 s68, s32, 1
    s_lshl_b32 s68, s68, 10
    s_mov_b32 s62, 2048
    s_mov_b32 s63, 0x20000
    s_waitcnt lgkmcnt(0)
    s_mov_b32 s60, s4
    s_mov_b32 s61, s5
    buffer_load_dwordx4 v[32:35], v1, s[60:63], s68 offen
    s_barrier
    s_add_u32 s68, s68, 147456
    v_add_u32 v4, s68, v1
    s_mov_b32 s68, 0x3b000000
    s_mov_b32 s69, 0x3727c5ac
    s_waitcnt vmcnt(0)
    v_lshlrev_b32 v40, 16, v32
    v_and_b32 v41, 0xffff0000, v32
    v_lshlrev_b32 v42, 16, v33
    v_and_b32 v43, 0xffff0000, v33
    v_lshlrev_b32 v44, 16, v34
    v_and_b32 v45, 0xffff0000, v34
    v_lshlrev_b32 v46, 16, v35
    v_and_b32 v47, 0xffff0000, v35
    v_add_f32 v5, v40, v41
    v_add_f32 v6, v42, v43
    v_add_f32 v7, v44, v45
    v_add_f32 v8, v46, v47
    v_add_f32 v5, v5, v6
    v_add_f32 v7, v7, v8
    v_add_f32 v5, v5, v7
    s_nop 1
    v_add_f32_dpp v5, v5, v5 row_ror:8 row_mask:0xf bank_mask:0xf
    s_nop 1
    v_add_f32_dpp v5, v5, v5 row_ror:4 row_mask:0xf bank_mask:0xf
    s_nop 1
    v_add_f32_dpp v5, v5, v5 row_ror:2 row_mask:0xf bank_mask:0xf
    s_nop 1
    v_add_f32_dpp v5, v5, v5 row_ror:1 row_mask:0xf bank_mask:0xf
    v_mov_b32 v6, v5
    s_nop 1
    v_permlane32_swap_b32 v5, v6
    v_add_f32 v5, v5, v6
    v_mov_b32 v6, v5
    s_nop 1
    v_permlane16_swap_b32 v5, v6
    v_add_f32 v5, v5, v6
    v_mul_f32 v5, s68, v5
    v_sub_f32 v56, v40, v5
    v_sub_f32 v57, v41, v5
    v_sub_f32 v58, v42, v5
    v_sub_f32 v59, v43, v5
    v_sub_f32 v60, v44, v5
    v_sub_f32 v61, v45, v5
    v_sub_f32 v62, v46, v5
    v_sub_f32 v63, v47, v5
    v_mul_f32 v6, v56, v56
    v_mul_f32 v7, v57, v57
    v_fmac_f32 v6, v58, v58
    v_fmac_f32 v7, v59, v59
    v_fmac_f32 v6, v60, v60
    v_fmac_f32 v7, v61, v61
    v_fmac_f32 v6, v62, v62
    v_fmac_f32 v7, v63, v63
    v_add_f32 v6, v6, v7
    v_cvt_pk_bf16_f32 v5, v5, v5
    v_and_b32 v5, 0xffff0000, v5
    v_add_f32_dpp v6, v6, v6 row_ror:8 row_mask:0xf bank_mask:0xf
    v_sub_f32 v40, v40, v5
    v_sub_f32 v41, v41, v5
    v_add_f32_dpp v6, v6, v6 row_ror:4 row_mask:0xf bank_mask:0xf
    v_sub_f32 v42, v42, v5
    v_sub_f32 v43, v43, v5
    v_add_f32_dpp v6, v6, v6 row_ror:2 row_mask:0xf bank_mask:0xf
    v_sub_f32 v44, v44, v5
    v_sub_f32 v45, v45, v5
    v_add_f32_dpp v6, v6, v6 row_ror:1 row_mask:0xf bank_mask:0xf
    v_sub_f32 v46, v46, v5
    v_sub_f32 v47, v47, v5
    v_mov_b32 v7, v6
    s_nop 1
    v_permlane32_swap_b32 v6, v7
    v_add_f32 v6, v6, v7
    v_mov_b32 v7, v6
    s_nop 1
    v_permlane16_swap_b32 v6, v7
    v_add_f32 v6, v6, v7
    v_mul_f32 v6, s68, v6
    v_cvt_pk_bf16_f32 v6, v6, v6
    v_and_b32 v6, 0xffff0000, v6
    v_add_f32 v6, s69, v6
    v_cvt_pk_bf16_f32 v6, v6, v6
    v_and_b32 v6, 0xffff0000, v6
    v_sqrt_f32 v6, v6
    v_cvt_pk_bf16_f32 v32, v40, v41
    v_cvt_pk_bf16_f32 v33, v42, v43
    v_cvt_pk_bf16_f32 v34, v44, v45
    v_cvt_pk_bf16_f32 v35, v46, v47
    v_cvt_pk_bf16_f32 v6, v6, v6
    v_and_b32 v6, 0xffff0000, v6
    v_rcp_f32 v7, v6
    v_lshlrev_b32 v40, 16, v32
    v_and_b32 v41, 0xffff0000, v32
    v_lshlrev_b32 v42, 16, v33
    v_and_b32 v43, 0xffff0000, v33
    v_lshlrev_b32 v44, 16, v34
    v_and_b32 v45, 0xffff0000, v34
    v_lshlrev_b32 v46, 16, v35
    v_and_b32 v47, 0xffff0000, v35
    v_mul_f32 v56, v40, v7
    v_mul_f32 v57, v41, v7
    v_mul_f32 v58, v42, v7
    v_mul_f32 v59, v43, v7
    v_mul_f32 v60, v44, v7
    v_mul_f32 v61, v45, v7
    v_mul_f32 v62, v46, v7
    v_mul_f32 v63, v47, v7
    v_fma_f32 v40, -v56, v6, v40
    v_fma_f32 v41, -v57, v6, v41
    v_fma_f32 v42, -v58, v6, v42
    v_fma_f32 v43, -v59, v6, v43
    v_fma_f32 v44, -v60, v6, v44
    v_fma_f32 v45, -v61, v6, v45
    v_fma_f32 v46, -v62, v6, v46
    v_fma_f32 v47, -v63, v6, v47
    v_fmac_f32 v56, v40, v7
    v_fmac_f32 v57, v41, v7
    v_fmac_f32 v58, v42, v7
    v_fmac_f32 v59, v43, v7
    v_fmac_f32 v60, v44, v7
    v_fmac_f32 v61, v45, v7
    v_fmac_f32 v62, v46, v7
    v_fmac_f32 v63, v47, v7
    v_cvt_pk_bf16_f32 v32, v56, v57
    v_cvt_pk_bf16_f32 v33, v58, v59
    v_cvt_pk_bf16_f32 v34, v60, v61
    v_cvt_pk_bf16_f32 v35, v62, v63
    ds_write_b128 v4, v[32:35]
    s_mov_b64 exec, 1
    ds_add_u32 v25, v26 offset:16
    s_mov_b64 exec, -1
    s_cmp_eq_u32 s39, 1
    s_cbranch_scc1 L_headL1
    s_branch L_tail1
L_tail0:
    s_waitcnt lgkmcnt(0)
    s_barrier
L_tail1:
    s_mov_b32 s44, s6
    s_mov_b32 s45, s7
    s_mov_b32 s46, 16777216
    s_mov_b32 s47, 0x20000
    s_lshl_b32 s68, s79, 2
    s_add_u32 s68, s68, 0
    s_and_b32 s69, s68, 7
    s_lshl_b32 s69, s69, 1
    s_lshr_b32 s70, s68, 3
    s_or_b32 s69, s69, s70
    s_lshl_b32 s69, s69, 4
    v_xor_b32 v252, s69, v1
    s_lshl_b32 s68, s79, 2
    s_add_u32 s68, s68, 1
    s_and_b32 s69, s68, 7
    s_lshl_b32 s69, s69, 1
    s_lshr_b32 s70, s68, 3
    s_or_b32 s69, s69, s70
    s_lshl_b32 s69, s69, 4
    v_xor_b32 v253, s69, v1
    s_lshl_b32 s68, s79, 2
    s_add_u32 s68, s68, 2
    s_and_b32 s69, s68, 7
    s_lshl_b32 s69, s69, 1
    s_lshr_b32 s70, s68, 3
    s_or_b32 s69, s69, s70
    s_lshl_b32 s69, s69, 4
    v_xor_b32 v254, s69, v1
    s_lshl_b32 s68, s79, 2
    s_add_u32 s68, s68, 3
    s_and_b32 s69, s68, 7
    s_lshl_b32 s69, s69, 1
    s_lshr_b32 s70, s68, 3
    s_or_b32 s69, s69, s70
    s_lshl_b32 s69, s69, 4
    v_xor_b32 v255, s69, v1
    s_lshl_b32 s70, s33, 17
    s_lshl_b32 s71, s79, 12
    s_add_u32 s70, s70, s71
    s_load_dword s36, s[28:29], 0
    s_cmp_eq_u32 s39, 0
    s_cbranch_scc1 L_tA0
    s_branch L_ckvgo
L_tA0:
    s_mov_b32 s48, s10
    s_mov_b32 s49, s11
    s_mov_b32 s50, 4194304
    s_mov_b32 s51, 0x20000
    v_lshlrev_b32 v6, 13, v3
    v_lshl_add_u32 v6, v2, 4, v6
    s_and_b32 s69, s79, 1
    s_lshl_b32 s69, s69, 2
    s_add_u32 s72, s69, 0
    s_lshl_b32 s72, s72, 4
    v_xor_b32 v192, s72, v6
    s_add_u32 s72, s69, 8
    s_lshl_b32 s72, s72, 4
    v_xor_b32 v193, s72, v6
    s_add_u32 s72, s69, 1
    s_lshl_b32 s72, s72, 4
    v_xor_b32 v194, s72, v6
    s_add_u32 s72, s69, 9
    s_lshl_b32 s72, s72, 4
    v_xor_b32 v195, s72, v6
    s_add_u32 s72, s69, 2
    s_lshl_b32 s72, s72, 4
    v_xor_b32 v196, s72, v6
    s_add_u32 s72, s69, 10
    s_lshl_b32 s72, s72, 4
    v_xor_b32 v197, s72, v6
    s_add_u32 s72, s69, 3
    s_lshl_b32 s72, s72, 4
    v_xor_b32 v198, s72, v6
    s_add_u32 s72, s69, 11
    s_lshl_b32 s72, s72, 4
    v_xor_b32 v199, s72, v6
    s_lshl_b32 s73, s78, 20
    s_lshl_b32 s74, s79, 18
    s_add_u32 s73, s73, s74
    s_lshl_b32 s74, s34, 8
    s_add_u32 s73, s73, s74
    s_and_b32 s74, s79, 1
    s_lshl_b32 s74, s74, 13
    s_cmp_lt_u32 s79, 2
    s_cselect_b32 s75, 0x4000, 0
    s_add_u32 s74, s74, s75
    s_add_u32 s74, s74, 114688
L_w10:
    ds_read_b32 v27, v25 offset:20
    s_waitcnt lgkmcnt(0)
    v_readfirstlane_b32 s68, v27
    s_nop 0
    s_cmp_lt_u32 s68, 4
    s_cbranch_scc1 L_w10
    s_mov_b32 m0, s74
    s_add_u32 s74, s74, 1024
    buffer_load_dwordx4 v192, s[48:51], s73 offen  lds
    s_add_u32 s73, s73, 0x8000
    s_mov_b32 m0, s74
    s_add_u32 s74, s74, 1024
    buffer_load_dwordx4 v193, s[48:51], s73 offen  lds
    s_add_u32 s73, s73, 0x8000
    s_mov_b32 m0, s74
    s_add_u32 s74, s74, 1024
    buffer_load_dwordx4 v194, s[48:51], s73 offen  lds
    s_add_u32 s73, s73, 0x8000
    s_mov_b32 m0, s74
    s_add_u32 s74, s74, 1024
    buffer_load_dwordx4 v195, s[48:51], s73 offen  lds
    s_add_u32 s73, s73, 0x8000
    s_mov_b32 m0, s74
    s_add_u32 s74, s74, 1024
    buffer_load_dwordx4 v196, s[48:51], s73 offen  lds
    s_add_u32 s73, s73, 0x8000
    s_mov_b32 m0, s74
    s_add_u32 s74, s74, 1024
    buffer_load_dwordx4 v197, s[48:51], s73 offen  lds
    s_add_u32 s73, s73, 0x8000
    s_mov_b32 m0, s74
    s_add_u32 s74, s74, 1024
    buffer_load_dwordx4 v198, s[48:51], s73 offen  lds
    s_add_u32 s73, s73, 0x8000
    s_mov_b32 m0, s74
    s_add_u32 s74, s74, 1024
    buffer_load_dwordx4 v199, s[48:51], s73 offen  lds
    s_add_u32 s73, s73, 0x8000
L_ckvgo:
    s_add_u32 s72, s70, 0
    s_mov_b32 m0, s71
    s_add_u32 s71, s71, 0x4000
    buffer_load_dwordx4 v252, s[44:47], s72 offen offset:0  lds
    buffer_load_dwordx4 v253, s[44:47], s72 offen offset:1024  lds
    buffer_load_dwordx4 v254, s[44:47], s72 offen offset:2048  lds
    buffer_load_dwordx4 v255, s[44:47], s72 offen offset:3072  lds
    s_cmp_eq_u32 s39, 1
    s_cbranch_scc1 L_noukl
    s_waitcnt vmcnt(4)
    s_mov_b64 exec, 1
    ds_add_u32 v25, v26 offset:8
    s_mov_b64 exec, -1
L_noukl:
    s_add_u32 s72, s70, 16384
    s_mov_b32 m0, s71
    s_add_u32 s71, s71, 0x4000
    buffer_load_dwordx4 v252, s[44:47], s72 offen offset:0  lds
    buffer_load_dwordx4 v253, s[44:47], s72 offen offset:1024  lds
    buffer_load_dwordx4 v254, s[44:47], s72 offen offset:2048  lds
    buffer_load_dwordx4 v255, s[44:47], s72 offen offset:3072  lds
    s_mov_b32 s40, s28
    s_mov_b32 s41, s29
    s_mov_b32 s42, 268435456
    s_mov_b32 s43, 0x20000
    v_and_b32 v27, 4, v0
    v_cmp_eq_u32 vcc, 0, v27
    v_mov_b32 v28, 0xffff
    v_mov_b32 v29, 0xffff0000
    v_cndmask_b32 v20, 0, v28, vcc
    v_cndmask_b32 v22, 0, v29, vcc
    v_xor_b32 v21, v20, v28
    v_xor_b32 v23, v22, v29
    v_and_b32 v27, 3, v0
    v_mul_u32_u24 v24, 0x5555, v27
    v_lshrrev_b32 v12, 2, v0
    v_and_b32 v13, 7, v12
    v_lshlrev_b32 v13, 1, v13
    v_lshrrev_b32 v14, 3, v12
    v_or_b32 v13, v13, v14
    v_bfe_u32 v14, v0, 1, 1
    v_xor_b32 v13, v13, v14
    v_lshlrev_b32 v13, 4, v13
    v_lshl_add_u32 v13, v12, 10, v13
    v_and_b32 v14, 1, v0
    v_lshl_add_u32 v13, v14, 3, v13
    s_lshl_b32 s68, s79, 8
    v_add_u32 v4, s68, v13
    v_xor_b32 v5, 32, v4
    v_xor_b32 v6, 64, v4
    v_xor_b32 v7, 96, v4
    v_xor_b32 v8, 128, v4
    v_xor_b32 v9, 160, v4
    v_xor_b32 v10, 192, v4
    v_xor_b32 v11, 224, v4
    v_lshlrev_b32 v12, 19, v3
    v_lshl_add_u32 v12, v2, 4, v12
    v_mov_b32 v13, 0xfffefffe
    v_add_u32 v14, 149504, v1
    s_lshl_b32 s73, s33, 8
    s_lshl_b32 s68, s39, 21
    s_add_u32 s73, s73, s68
    s_lshl_b32 s68, s79, 15
    s_add_u32 s73, s73, s68
    s_add_u32 s73, s73, 2097152
    s_mov_b32 s74, 0x07060302
    s_waitcnt lgkmcnt(0)
    s_add_u32 s36, s36, 1
    s_and_b32 s68, s36, 0xff
    v_and_b32 v27, 7, v0
    v_xor_b32 v27, s68, v27
    v_bfe_u32 v28, v27, 0, 1
    v_bfe_u32 v29, v27, 1, 1
    v_lshl_or_b32 v16, v29, 16, v28
    v_bfe_u32 v28, v27, 2, 1
    v_bfe_u32 v29, v27, 3, 1
    v_lshl_or_b32 v17, v29, 16, v28
    v_bfe_u32 v28, v27, 4, 1
    v_bfe_u32 v29, v27, 5, 1
    v_lshl_or_b32 v18, v29, 16, v28
    v_bfe_u32 v28, v27, 6, 1
    v_bfe_u32 v29, v27, 7, 1
    v_lshl_or_b32 v19, v29, 16, v28
    v_lshlrev_b32 v15, 7, v0
    v_lshlrev_b32 v30, 13, v0
    s_add_u32 s68, s79, 1
    s_and_b32 s68, s68, 2
    s_cselect_b32 s75, s65, 0
    s_add_u32 s72, s70, 32768
    s_mov_b32 m0, s71
    s_add_u32 s71, s71, 0x4000
    buffer_load_dwordx4 v252, s[44:47], s72 offen offset:0  lds
    buffer_load_dwordx4 v253, s[44:47], s72 offen offset:1024  lds
    buffer_load_dwordx4 v254, s[44:47], s72 offen offset:2048  lds
    buffer_load_dwordx4 v255, s[44:47], s72 offen offset:3072  lds
    s_add_u32 s72, s70, 49152
    s_mov_b32 m0, s71
    s_add_u32 s71, s71, 0x4000
    buffer_load_dwordx4 v252, s[44:47], s72 offen offset:0  lds
    buffer_load_dwordx4 v253, s[44:47], s72 offen offset:1024  lds
    buffer_load_dwordx4 v254, s[44:47], s72 offen offset:2048  lds
    buffer_load_dwordx4 v255, s[44:47], s72 offen offset:3072  lds
    s_cmp_eq_u32 s39, 1
    s_cbranch_scc1 L_gp11
L_w12:
    ds_read_b32 v27, v25 offset:36
    s_waitcnt lgkmcnt(0)
    v_readfirstlane_b32 s68, v27
    s_nop 0
    s_cmp_lt_u32 s68, 2
    s_cbranch_scc1 L_w12
L_gp11:
    s_add_u32 s72, s70, 65536
    s_mov_b32 m0, s71
    s_add_u32 s71, s71, 0x4000
    buffer_load_dwordx4 v252, s[44:47], s72 offen offset:0  lds
    buffer_load_dwordx4 v253, s[44:47], s72 offen offset:1024  lds
    buffer_load_dwordx4 v254, s[44:47], s72 offen offset:2048  lds
    buffer_load_dwordx4 v255, s[44:47], s72 offen offset:3072  lds
    s_cmp_eq_u32 s39, 1
    s_cselect_b32 s72, 5, 7
    s_lshl_b32 s72, s72, 14
    s_add_u32 s72, s72, s70
    s_mov_b32 m0, s71
    s_add_u32 s71, s71, 0x4000
    buffer_load_dwordx4 v252, s[44:47], s72 offen offset:0  lds
    buffer_load_dwordx4 v253, s[44:47], s72 offen offset:1024  lds
    buffer_load_dwordx4 v254, s[44:47], s72 offen offset:2048  lds
    buffer_load_dwordx4 v255, s[44:47], s72 offen offset:3072  lds
    s_add_u32 s72, s70, 98304
    s_mov_b32 m0, s71
    s_add_u32 s71, s71, 0x4000
    buffer_load_dwordx4 v252, s[44:47], s72 offen offset:0  lds
    buffer_load_dwordx4 v253, s[44:47], s72 offen offset:1024  lds
    buffer_load_dwordx4 v254, s[44:47], s72 offen offset:2048  lds
    buffer_load_dwordx4 v255, s[44:47], s72 offen offset:3072  lds
L_w13:
    ds_read_b32 v27, v25 offset:4
    s_waitcnt lgkmcnt(0)
    v_readfirstlane_b32 s68, v27
    s_nop 0
    s_cmp_lt_u32 s68, 2
    s_cbranch_scc1 L_w13
    s_cmp_eq_u32 s39, 1
    s_cselect_b32 s72, 7, 5
    s_lshl_b32 s72, s72, 14
    s_add_u32 s72, s72, s70
    s_mov_b32 m0, s71
    s_add_u32 s71, s71, 0x4000
    buffer_load_dwordx4 v252, s[44:47], s72 offen offset:0  lds
    buffer_load_dwordx4 v253, s[44:47], s72 offen offset:1024  lds
    buffer_load_dwordx4 v254, s[44:47], s72 offen offset:2048  lds
    buffer_load_dwordx4 v255, s[44:47], s72 offen offset:3072  lds
    s_mov_b64 exec, 1
    ds_add_u32 v25, v26 offset:24
    s_mov_b64 exec, -1
    s_waitcnt vmcnt(16)
    s_mov_b64 exec, 1
    ds_add_u32 v25, v26 offset:12
    s_mov_b64 exec, -1
L_w14:
    ds_read_b32 v27, v25 offset:12
    s_waitcnt lgkmcnt(0)
    v_readfirstlane_b32 s68, v27
    s_nop 0
    s_cmp_lt_u32 s68, 4
    s_cbranch_scc1 L_w14
    ds_read_b64_tr_b16 v[32:33], v4 offset:0
    ds_read_b64_tr_b16 v[34:35], v4 offset:16384
    ds_read_b64_tr_b16 v[36:37], v4 offset:32768
    ds_read_b64_tr_b16 v[38:39], v4 offset:49152
    ds_read_b64_tr_b16 v[48:49], v5 offset:0
    ds_read_b64_tr_b16 v[50:51], v5 offset:16384
    ds_read_b64_tr_b16 v[52:53], v5 offset:32768
    ds_read_b64_tr_b16 v[54:55], v5 offset:49152
    ds_read_b64_tr_b16 v[64:65], v6 offset:0
    ds_read_b64_tr_b16 v[66:67], v6 offset:16384
    ds_read_b64_tr_b16 v[68:69], v6 offset:32768
    ds_read_b64_tr_b16 v[70:71], v6 offset:49152
    ds_read_b64_tr_b16 v[80:81], v7 offset:0
    ds_read_b64_tr_b16 v[82:83], v7 offset:16384
    ds_read_b64_tr_b16 v[84:85], v7 offset:32768
    ds_read_b64_tr_b16 v[86:87], v7 offset:49152
    ds_read_b64_tr_b16 v[96:97], v8 offset:0
    ds_read_b64_tr_b16 v[98:99], v8 offset:16384
    ds_read_b64_tr_b16 v[100:101], v8 offset:32768
    ds_read_b64_tr_b16 v[102:103], v8 offset:49152
    ds_read_b64_tr_b16 v[112:113], v9 offset:0
    ds_read_b64_tr_b16 v[114:115], v9 offset:16384
    ds_read_b64_tr_b16 v[116:117], v9 offset:32768
    ds_read_b64_tr_b16 v[118:119], v9 offset:49152
    ds_read_b64_tr_b16 v[128:129], v10 offset:0
    ds_read_b64_tr_b16 v[130:131], v10 offset:16384
    ds_read_b64_tr_b16 v[132:133], v10 offset:32768
    ds_read_b64_tr_b16 v[134:135], v10 offset:49152
    ds_read_b64_tr_b16 v[144:145], v11 offset:0
    ds_read_b64_tr_b16 v[146:147], v11 offset:16384
    ds_read_b64_tr_b16 v[148:149], v11 offset:32768
    ds_read_b64_tr_b16 v[150:151], v11 offset:49152
    v_add_u32 v4, 0x10000, v4
    v_add_u32 v5, 0x10000, v5
    v_add_u32 v6, 0x10000, v6
    v_add_u32 v7, 0x10000, v7
    v_add_u32 v8, 0x10000, v8
    v_add_u32 v9, 0x10000, v9
    v_add_u32 v10, 0x10000, v10
    v_add_u32 v11, 0x10000, v11
    s_and_b32 s68, s36, 0xff
    s_xor_b32 s69, s68, 0
    v_mov_b32 v252, s69
    s_xor_b32 s69, s68, 85
    v_mov_b32 v253, s69
    s_xor_b32 s69, s68, 170
    v_mov_b32 v254, s69
    s_xor_b32 s69, s68, 255
    v_mov_b32 v255, s69
L_w15:
    ds_read_b32 v27, v25 offset:44
    s_waitcnt lgkmcnt(0)
    v_readfirstlane_b32 s68, v27
    s_nop 0
    s_cmp_lt_u32 s68, 4
    s_cbranch_scc1 L_w15
    s_cmp_eq_u32 s75, 0
    s_cbranch_scc1 L_xg17
    s_cmp_eq_u32 s79, 1
    s_cbranch_scc1 L_gate
    s_mov_b32 s56, s20
    s_mov_b32 s57, s21
    s_mov_b32 s58, 1835008
    s_mov_b32 s59, 0x20000
    s_branch L_gu
L_gate:
    s_mov_b32 s56, s18
    s_mov_b32 s57, s19
    s_mov_b32 s58, 1835008
    s_mov_b32 s59, 0x20000
L_gu:
    v_lshrrev_b32 v28, 1, v3
    v_lshlrev_b32 v28, 4, v28
    v_and_b32 v29, 1, v3
    v_add_u32 v28, v28, v29
    v_mul_u32_u24 v28, 3584, v28
    v_lshl_add_u32 v28, v2, 4, v28
    v_add_u32 v29, 114688, v28
    s_mul_i32 s68, s30, 229376
    s_lshl_b32 s69, s66, 8
    s_add_u32 s68, s68, s69
    buffer_load_dwordx4 v[176:179], v28, s[56:59], s68 offen
    buffer_load_dwordx4 v[180:183], v29, s[56:59], s68 offen
    s_add_u32 s68, s68, 7168
    buffer_load_dwordx4 v[184:187], v28, s[56:59], s68 offen
    buffer_load_dwordx4 v[188:191], v29, s[56:59], s68 offen
    s_add_u32 s68, s68, 7168
    buffer_load_dwordx4 v[192:195], v28, s[56:59], s68 offen
    buffer_load_dwordx4 v[196:199], v29, s[56:59], s68 offen
    s_add_u32 s68, s68, 7168
    buffer_load_dwordx4 v[200:203], v28, s[56:59], s68 offen
    buffer_load_dwordx4 v[204:207], v29, s[56:59], s68 offen
    s_add_u32 s68, s68, 7168
    buffer_load_dwordx4 v[208:211], v28, s[56:59], s68 offen
    buffer_load_dwordx4 v[212:215], v29, s[56:59], s68 offen
    s_add_u32 s68, s68, 7168
    buffer_load_dwordx4 v[216:219], v28, s[56:59], s68 offen
    buffer_load_dwordx4 v[220:223], v29, s[56:59], s68 offen
    s_add_u32 s68, s68, 7168
    buffer_load_dwordx4 v[224:227], v28, s[56:59], s68 offen
    buffer_load_dwordx4 v[228:231], v29, s[56:59], s68 offen
    s_add_u32 s68, s68, 7168
    buffer_load_dwordx4 v[232:235], v28, s[56:59], s68 offen
    buffer_load_dwordx4 v[236:239], v29, s[56:59], s68 offen
    s_branch L_xe16
L_xg17:
    s_cmp_eq_u32 s39, 1
    s_cbranch_scc1 L_xu18
    s_cmp_ge_u32 s79, 2
    s_cbranch_scc1 L_xu18
    s_mov_b32 s56, s12
    s_mov_b32 s57, s13
    s_mov_b32 s58, 4194304
    s_mov_b32 s59, 0x20000
    v_lshlrev_b32 v28, 17, v3
    v_lshl_add_u32 v28, v2, 4, v28
    v_add_u32 v29, 0x80000, v28
    s_lshl_b32 s68, s78, 20
    s_lshl_b32 s69, s34, 8
    s_add_u32 s68, s68, s69
    s_lshl_b32 s69, s79, 16
    s_add_u32 s68, s68, s69
    buffer_load_dwordx4 v[176:179], v28, s[56:59], s68 offen
    buffer_load_dwordx4 v[180:183], v29, s[56:59], s68 offen
    s_add_u32 s68, s68, 0x2000
    buffer_load_dwordx4 v[184:187], v28, s[56:59], s68 offen
    buffer_load_dwordx4 v[188:191], v29, s[56:59], s68 offen
    s_add_u32 s68, s68, 0x2000
    buffer_load_dwordx4 v[192:195], v28, s[56:59], s68 offen
    buffer_load_dwordx4 v[196:199], v29, s[56:59], s68 offen
    s_add_u32 s68, s68, 0x2000
    buffer_load_dwordx4 v[200:203], v28, s[56:59], s68 offen
    buffer_load_dwordx4 v[204:207], v29, s[56:59], s68 offen
    s_add_u32 s68, s68, 0x2000
    buffer_load_dwordx4 v[208:211], v28, s[56:59], s68 offen
    buffer_load_dwordx4 v[212:215], v29, s[56:59], s68 offen
    s_add_u32 s68, s68, 0x2000
    buffer_load_dwordx4 v[216:219], v28, s[56:59], s68 offen
    buffer_load_dwordx4 v[220:223], v29, s[56:59], s68 offen
    s_add_u32 s68, s68, 0x2000
    buffer_load_dwordx4 v[224:227], v28, s[56:59], s68 offen
    buffer_load_dwordx4 v[228:231], v29, s[56:59], s68 offen
    s_add_u32 s68, s68, 0x2000
    buffer_load_dwordx4 v[232:235], v28, s[56:59], s68 offen
    buffer_load_dwordx4 v[236:239], v29, s[56:59], s68 offen
    s_branch L_xe16
L_xu18:
    s_cmp_lg_u32 s79, 3
    s_cbranch_scc1 L_xe16
    s_cmp_eq_u32 s39, 1
    s_cbranch_scc1 L_xl19
    s_branch L_xe16
L_xl19:
L_xe16:
    s_cmp_eq_u32 s75, 1
    s_cbranch_scc1 L_vm16
    s_lshl_b32 s68, s39, 1
    s_add_u32 s68, s68, s79
    s_cmp_lt_u32 s68, 2
    s_cbranch_scc1 L_vm16
    s_cmp_lg_u32 s79, 3
    s_cbranch_scc1 L_vm0
    s_cmp_eq_u32 s39, 1
    s_cbranch_scc1 L_vmL
    s_waitcnt vmcnt(0)
    s_branch L_vm16
L_vm0:
    s_waitcnt vmcnt(0)
L_vmL:
    s_waitcnt vmcnt(0)
L_vm16:
    s_waitcnt vmcnt(16)
    s_barrier
    s_cmp_lg_u32 s79, 3
    s_cbranch_scc1 L_xe20
    s_cmp_eq_u32 s39, 1
    s_cbranch_scc1 L_xl21
    s_branch L_xe20
L_xl21:
    s_mov_b32 s56, s14
    s_mov_b32 s57, s15
    s_mov_b32 s58, 4194304
    s_mov_b32 s59, 0x20000
    s_lshl_b32 s68, s34, 17
    s_lshl_b32 s69, s78, 15
    s_add_u32 s68, s68, s69
    s_add_u32 s68, s68, 16384
    buffer_load_dword v178, v15, s[56:59], s68 offen
    s_mov_b32 s56, s14
    s_mov_b32 s57, s15
    s_mov_b32 s58, 4194304
    s_mov_b32 s59, 0x20000
    s_lshl_b32 s68, s34, 17
    s_lshl_b32 s69, s78, 15
    s_add_u32 s68, s68, s69
    s_add_u32 s68, s68, 24576
    buffer_load_dword v179, v15, s[56:59], s68 offen
L_xe20:
    s_barrier
    ds_read_b64_tr_b16 v[40:41], v4 offset:0
    ds_read_b64_tr_b16 v[42:43], v4 offset:16384
    ds_read_b64_tr_b16 v[44:45], v4 offset:32768
    ds_read_b64_tr_b16 v[46:47], v4 offset:49152
    ds_read_b64_tr_b16 v[56:57], v5 offset:0
    ds_read_b64_tr_b16 v[58:59], v5 offset:16384
    ds_read_b64_tr_b16 v[60:61], v5 offset:32768
    ds_read_b64_tr_b16 v[62:63], v5 offset:49152
    ds_read_b64_tr_b16 v[72:73], v6 offset:0
    ds_read_b64_tr_b16 v[74:75], v6 offset:16384
    ds_read_b64_tr_b16 v[76:77], v6 offset:32768
    ds_read_b64_tr_b16 v[78:79], v6 offset:49152
    ds_read_b64_tr_b16 v[88:89], v7 offset:0
    ds_read_b64_tr_b16 v[90:91], v7 offset:16384
    ds_read_b64_tr_b16 v[92:93], v7 offset:32768
    ds_read_b64_tr_b16 v[94:95], v7 offset:49152
    ds_read_b64_tr_b16 v[104:105], v8 offset:0
    ds_read_b64_tr_b16 v[106:107], v8 offset:16384
    ds_read_b64_tr_b16 v[108:109], v8 offset:32768
    ds_read_b64_tr_b16 v[110:111], v8 offset:49152
    ds_read_b64_tr_b16 v[120:121], v9 offset:0
    ds_read_b64_tr_b16 v[122:123], v9 offset:16384
    ds_read_b64_tr_b16 v[124:125], v9 offset:32768
    ds_read_b64_tr_b16 v[126:127], v9 offset:49152
    ds_read_b64_tr_b16 v[136:137], v10 offset:0
    ds_read_b64_tr_b16 v[138:139], v10 offset:16384
    ds_read_b64_tr_b16 v[140:141], v10 offset:32768
    ds_read_b64_tr_b16 v[142:143], v10 offset:49152
    ds_read_b64_tr_b16 v[152:153], v11 offset:0
    ds_read_b64_tr_b16 v[154:155], v11 offset:16384
    ds_read_b64_tr_b16 v[156:157], v11 offset:32768
    ds_read_b64_tr_b16 v[158:159], v11 offset:49152
    s_barrier
    v_mov_b32 v240, 0
    v_mov_b32 v241, 0
    v_mov_b32 v242, 0
    v_mov_b32 v243, 0
    s_lshl_b32 s68, s79, 10
    s_add_u32 s69, s68, 131072
    v_add_u32 v28, s69, v1
    s_add_u32 s69, s68, 156288
    v_add_u32 v29, s69, v1
    ds_write_b128 v28, v[240:243]
    ds_write_b128 v29, v[240:243]
    s_cmp_ge_u32 s79, 2
    s_cbranch_scc1 L_noz
    ds_write_b128 v28, v[240:243] offset:4096
    ds_write_b128 v29, v[240:243] offset:4096
L_noz:
    s_waitcnt lgkmcnt(0)
    s_barrier
    s_setprio 2
    ds_read_b128 v[160:163], v14 offset:0
    ds_read_b128 v[164:167], v14 offset:1024
    ds_read_b128 v[168:171], v14 offset:2048
    ds_read_b128 v[172:175], v14 offset:3072
    s_waitcnt lgkmcnt(3)
    v_mfma_f32_16x16x32_bf16 v[240:243], v[160:163], v[32:35], 0
    s_waitcnt lgkmcnt(2)
    v_mfma_f32_16x16x32_bf16 v[240:243], v[164:167], v[36:39], v[240:243]
    s_waitcnt lgkmcnt(1)
    v_mfma_f32_16x16x32_bf16 v[240:243], v[168:171], v[40:43], v[240:243]
    s_waitcnt lgkmcnt(0)
    v_mfma_f32_16x16x32_bf16 v[240:243], v[172:175], v[44:47], v[240:243]
    v_mfma_f32_16x16x32_bf16 v[244:247], v[160:163], v[48:51], 0
    v_mfma_f32_16x16x32_bf16 v[244:247], v[164:167], v[52:55], v[244:247]
    v_mfma_f32_16x16x32_bf16 v[244:247], v[168:171], v[56:59], v[244:247]
    v_mfma_f32_16x16x32_bf16 v[244:247], v[172:175], v[60:63], v[244:247]
    v_mfma_f32_16x16x32_bf16 v[48:51], v[160:163], v[64:67], 0
    v_mfma_f32_16x16x32_bf16 v[48:51], v[164:167], v[68:71], v[48:51]
    v_mfma_f32_16x16x32_bf16 v[48:51], v[168:171], v[72:75], v[48:51]
    v_mfma_f32_16x16x32_bf16 v[48:51], v[172:175], v[76:79], v[48:51]
    s_nop 3
    v_perm_b32 v32, v244, v240, s74
    v_perm_b32 v36, v245, v241, s74
    v_mfma_f32_16x16x32_bf16 v[52:55], v[160:163], v[80:83], 0
    v_perm_b32 v40, v246, v242, s74
    v_perm_b32 v44, v247, v243, s74
    v_mfma_f32_16x16x32_bf16 v[52:55], v[164:167], v[84:87], v[52:55]
    v_add_u32 v32, 0x10001, v32
    v_add_u32 v36, 0x10001, v36
    v_mfma_f32_16x16x32_bf16 v[52:55], v[168:171], v[88:91], v[52:55]
    v_add_u32 v40, 0x10001, v40
    v_add_u32 v44, 0x10001, v44
    v_mfma_f32_16x16x32_bf16 v[52:55], v[172:175], v[92:95], v[52:55]
    v_and_or_b32 v32, v32, v13, v16
    v_and_or_b32 v36, v36, v13, v16
    v_mfma_f32_16x16x32_bf16 v[56:59], v[160:163], v[96:99], 0
    v_and_or_b32 v40, v40, v13, v16
    v_and_or_b32 v44, v44, v13, v16
    v_mfma_f32_16x16x32_bf16 v[56:59], v[164:167], v[100:103], v[56:59]
    v_mfma_f32_16x16x32_bf16 v[56:59], v[168:171], v[104:107], v[56:59]
    v_mfma_f32_16x16x32_bf16 v[56:59], v[172:175], v[108:111], v[56:59]
    v_perm_b32 v33, v52, v48, s74
    v_perm_b32 v37, v53, v49, s74
    v_mfma_f32_16x16x32_bf16 v[60:63], v[160:163], v[112:115], 0
    v_perm_b32 v41, v54, v50, s74
    v_perm_b32 v45, v55, v51, s74
    v_mfma_f32_16x16x32_bf16 v[60:63], v[164:167], v[116:119], v[60:63]
    v_add_u32 v33, 0x10001, v33
    v_add_u32 v37, 0x10001, v37
    v_mfma_f32_16x16x32_bf16 v[60:63], v[168:171], v[120:123], v[60:63]
    v_add_u32 v41, 0x10001, v41
    v_add_u32 v45, 0x10001, v45
    v_mfma_f32_16x16x32_bf16 v[60:63], v[172:175], v[124:127], v[60:63]
    v_and_or_b32 v33, v33, v13, v17
    v_and_or_b32 v37, v37, v13, v17
    v_mfma_f32_16x16x32_bf16 v[64:67], v[160:163], v[128:131], 0
    v_and_or_b32 v41, v41, v13, v17
    v_and_or_b32 v45, v45, v13, v17
    v_mfma_f32_16x16x32_bf16 v[64:67], v[164:167], v[132:135], v[64:67]
    v_mfma_f32_16x16x32_bf16 v[64:67], v[168:171], v[136:139], v[64:67]
    v_mfma_f32_16x16x32_bf16 v[64:67], v[172:175], v[140:143], v[64:67]
    v_perm_b32 v34, v60, v56, s74
    v_perm_b32 v38, v61, v57, s74
    v_mfma_f32_16x16x32_bf16 v[68:71], v[160:163], v[144:147], 0
    v_perm_b32 v42, v62, v58, s74
    v_perm_b32 v46, v63, v59, s74
    v_mfma_f32_16x16x32_bf16 v[68:71], v[164:167], v[148:151], v[68:71]
    v_add_u32 v34, 0x10001, v34
    v_add_u32 v38, 0x10001, v38
    v_mfma_f32_16x16x32_bf16 v[68:71], v[168:171], v[152:155], v[68:71]
    v_add_u32 v42, 0x10001, v42
    v_add_u32 v46, 0x10001, v46
    v_mfma_f32_16x16x32_bf16 v[68:71], v[172:175], v[156:159], v[68:71]
    v_and_or_b32 v34, v34, v13, v18
    v_and_or_b32 v38, v38, v13, v18
    v_and_or_b32 v42, v42, v13, v18
    v_and_or_b32 v46, v46, v13, v18
    s_nop 3
    v_perm_b32 v35, v68, v64, s74
    v_add_u32 v35, 0x10001, v35
    v_and_or_b32 v35, v35, v13, v19
    buffer_store_dwordx4 v[32:35], v12, s[40:43], s73 offen sc1
    s_add_u32 s73, s73, 0x20000
    v_perm_b32 v39, v69, v65, s74
    v_add_u32 v39, 0x10001, v39
    v_and_or_b32 v39, v39, v13, v19
    buffer_store_dwordx4 v[36:39], v12, s[40:43], s73 offen sc1
    s_add_u32 s73, s73, 0x20000
    v_perm_b32 v43, v70, v66, s74
    v_add_u32 v43, 0x10001, v43
    v_and_or_b32 v43, v43, v13, v19
    buffer_store_dwordx4 v[40:43], v12, s[40:43], s73 offen sc1
    s_add_u32 s73, s73, 0x20000
    v_perm_b32 v47, v71, v67, s74
    v_add_u32 v47, 0x10001, v47
    v_and_or_b32 v47, v47, v13, v19
    buffer_store_dwordx4 v[44:47], v12, s[40:43], s73 offen sc1
    s_mov_b32 s76, 0
    s_mov_b32 s77, 0
    s_mov_b64 exec, 1
    ds_add_u32 v25, v26 offset:28
    s_mov_b64 exec, -1
    s_cmp_eq_u32 s39, 0
    s_cbranch_scc1 L_tA
    s_lshl_b32 s64, s66, 14
    s_lshl_b32 s69, s30, 11
    s_add_u32 s64, s64, s69
    s_add_u32 s64, s64, 131072
    s_cmp_eq_u32 s75, 0
    s_cbranch_scc1 L_nofp
    v_bfe_u32 v28, v0, 3, 1
    v_lshlrev_b32 v28, 10, v28
    v_lshl_add_u32 v28, v3, 5, v28
    s_lshl_b32 s69, s30, 7
    s_add_u32 s69, s69, 147456
    v_add_u32 v28, s69, v28
L_w22:
    ds_read_b32 v27, v25 offset:16
    ds_read_b128 v[168:171], v28
    ds_read_b128 v[172:175], v28 offset:16
    s_waitcnt lgkmcnt(0)
    v_readfirstlane_b32 s68, v27
    s_nop 0
    s_cmp_lt_u32 s68, 2
    s_cbranch_scc1 L_w22
    v_mov_b32 v248, 0
    v_mov_b32 v249, 0
    v_mov_b32 v250, 0
    v_mov_b32 v251, 0
    v_lshrrev_b32 v28, 1, v2
    v_lshlrev_b32 v28, 11, v28
    v_and_b32 v29, 1, v0
    v_lshl_add_u32 v28, v29, 6, v28
    v_lshl_add_u32 v28, v3, 4, v28
    s_lshl_b32 s68, s66, 14
    s_lshl_b32 s69, s30, 7
    s_add_u32 s68, s68, s69
    s_lshl_b32 s69, s79, 10
    s_add_u32 s68, s68, s69
    s_add_u32 s68, s68, 130048
    v_mov_b32 v29, 0xffffff00
    v_and_b32 v160, v168, v20
    v_and_b32 v161, v168, v21
    v_and_b32 v162, v168, v22
    v_and_b32 v163, v168, v23
    s_waitcnt vmcnt(4)
    v_and_b32 v164, v169, v20
    v_and_b32 v165, v169, v21
    v_and_b32 v166, v169, v22
    v_and_b32 v167, v169, v23
    v_smfmac_f32_16x16x64_bf16 v[248:251], v[160:163], v[176:183], v24
    v_and_b32 v160, v170, v20
    v_and_b32 v161, v170, v21
    v_and_b32 v162, v170, v22
    v_and_b32 v163, v170, v23
    v_smfmac_f32_16x16x64_bf16 v[248:251], v[164:167], v[184:191], v24
    v_and_b32 v164, v171, v20
    v_and_b32 v165, v171, v21
    v_and_b32 v166, v171, v22
    v_and_b32 v167, v171, v23
    v_smfmac_f32_16x16x64_bf16 v[248:251], v[160:163], v[192:199], v24
    v_and_b32 v160, v172, v20
    v_and_b32 v161, v172, v21
    v_and_b32 v162, v172, v22
    v_and_b32 v163, v172, v23
    v_smfmac_f32_16x16x64_bf16 v[248:251], v[164:167], v[200:207], v24
    v_and_b32 v164, v173, v20
    v_and_b32 v165, v173, v21
    v_and_b32 v166, v173, v22
    v_and_b32 v167, v173, v23
    v_smfmac_f32_16x16x64_bf16 v[248:251], v[160:163], v[208:215], v24
    v_and_b32 v160, v174, v20
    v_and_b32 v161, v174, v21
    v_and_b32 v162, v174, v22
    v_and_b32 v163, v174, v23
    v_smfmac_f32_16x16x64_bf16 v[248:251], v[164:167], v[216:223], v24
    v_and_b32 v164, v175, v20
    v_and_b32 v165, v175, v21
    v_and_b32 v166, v175, v22
    v_and_b32 v167, v175, v23
    v_smfmac_f32_16x16x64_bf16 v[248:251], v[160:163], v[224:231], v24
    s_nop 0
    v_smfmac_f32_16x16x64_bf16 v[248:251], v[164:167], v[232:239], v24
    s_nop 7
    v_and_or_b32 v248, v248, v29, v252
    v_and_or_b32 v249, v249, v29, v253
    v_and_or_b32 v250, v250, v29, v254
    v_and_or_b32 v251, v251, v29, v255
    buffer_store_dwordx4 v[248:251], v28, s[40:43], s68 offen sc1
L_nofp:
    s_cmp_eq_u32 s79, 1
    s_cselect_b32 s75, s65, 0
    s_mov_b64 exec, 1
    ds_add_u32 v25, v26 offset:52
    s_mov_b64 exec, -1
    s_cmp_eq_u32 s75, 0
    s_cbranch_scc1 L_b3l
    v_bfe_u32 v5, v0, 3, 1
    v_mul_u32_u24 v4, 2948, v5
    v_bfe_u32 v12, v0, 1, 1
    v_mul_u32_u24 v12, 1472, v12
    v_add_u32 v4, v4, v12
    v_and_b32 v12, 1, v0
    v_lshl_add_u32 v4, v12, 5, v4
    v_bfe_u32 v12, v0, 2, 1
    v_mul_u32_u24 v12, 80, v12
    v_add_u32 v4, v12, v4
    v_and_b32 v12, 1, v3
    v_lshl_add_u32 v4, v12, 4, v4
    v_lshrrev_b32 v12, 1, v3
    v_lshl_add_u32 v4, v12, 3, v4
    v_add_u32 v4, 157568, v4
L_w23:
    ds_read_b32 v27, v25 offset:32
    s_waitcnt lgkmcnt(0)
    v_readfirstlane_b32 s68, v27
    s_nop 0
    s_cmp_lt_u32 s68, 4
    s_cbranch_scc1 L_w23
    buffer_load_dwordx4 v[96:99], v1, s[40:43], s64 offen sc1
    buffer_load_dwordx4 v[100:103], v1, s[40:43], s64 offen offset:1024 sc1
L_fploop:
    s_add_u32 s77, s77, 1
    s_waitcnt vmcnt(0)
    v_xor_b32 v96, v96, v252
    v_xor_b32 v97, v97, v253
    v_xor_b32 v98, v98, v254
    v_xor_b32 v99, v99, v255
    v_xor_b32 v100, v100, v252
    v_xor_b32 v101, v101, v253
    v_xor_b32 v102, v102, v254
    v_xor_b32 v103, v103, v255
    v_or3_b32 v28, v96, v97, v98
    v_or3_b32 v28, v28, v99, v100
    v_or3_b32 v28, v28, v101, v102
    v_or_b32 v28, v28, v103
    v_and_b32 v28, 0xff, v28
    v_cmp_ne_u32 vcc, 0, v28
    s_cmp_gt_u32 s77, 200000
    s_cbranch_scc1 L_fpout
    s_cbranch_vccz L_fpout
    s_mov_b64 exec, vcc
    buffer_load_dwordx4 v[96:99], v1, s[40:43], s64 offen sc1
    buffer_load_dwordx4 v[100:103], v1, s[40:43], s64 offen offset:1024 sc1
    s_branch L_fploop
L_fpout:
    s_mov_b64 exec, -1
    v_permlane32_swap_b32 v96, v97
    v_permlane32_swap_b32 v98, v99
    v_permlane32_swap_b32 v100, v101
    v_permlane32_swap_b32 v102, v103
    v_add_f32 v96, v96, v97
    v_add_f32 v98, v98, v99
    v_add_f32 v100, v100, v101
    v_add_f32 v102, v102, v103
    v_permlane16_swap_b32 v96, v98
    s_nop 0
    v_permlane16_swap_b32 v100, v102
    v_add_f32 v96, v96, v98
    v_add_f32 v100, v100, v102
    s_nop 0
    v_add_f32_dpp v96, v96, v96 row_ror:8 row_mask:0xf bank_mask:0xf
    v_add_f32_dpp v100, v100, v100 row_ror:8 row_mask:0xf bank_mask:0xf
    v_cvt_pk_bf16_f32 v96, v96, v100
    v_lshlrev_b32 v100, 16, v96
    v_and_b32 v96, 0xffff0000, v96
    v_mul_f32 v96, v96, v100
    v_cvt_pk_bf16_f32 v96, v96, v96
    ds_write_b16 v4, v96
L_b3l:
    s_branch L_b3
L_tA:
    v_bfe_u32 v5, v0, 3, 1
    v_lshlrev_b32 v9, 8, v5
    v_lshl_add_u32 v9, v3, 5, v9
    s_lshl_b32 s74, s34, 11
    s_lshl_b32 s70, s79, 9
    s_add_u32 s74, s74, s70
    s_add_u32 s74, s74, 393216
    s_not_b32 s71, s36
    buffer_load_dwordx4 v[128:131], v9, s[40:43], s74 offen offset:0 sc1
    buffer_load_dwordx4 v[132:135], v9, s[40:43], s74 offen offset:16 sc1
    buffer_load_dwordx4 v[136:139], v9, s[40:43], s74 offen offset:128 sc1
    buffer_load_dwordx4 v[140:143], v9, s[40:43], s74 offen offset:144 sc1
    s_lshl_b32 s73, s33, 15
    s_lshl_b32 s69, s79, 13
    s_add_u32 s73, s73, s69
    s_add_u32 s73, s73, 2097152
    s_add_u32 s67, s73, 0x1000
    s_mov_b32 s72, 0x10001
    v_lshrrev_b32 v14, 1, v3
    v_and_b32 v13, 1, v3
    v_mul_u32_u24 v242, 80, v2
    v_lshl_add_u32 v242, v13, 5, v242
    s_lshl_b32 s68, s78, 2
    v_subrev_u32 v244, s68, v2
    v_and_b32 v244, 15, v244
    v_mul_u32_u24 v244, 80, v244
    v_lshl_add_u32 v244, v13, 5, v244
    v_mul_u32_u24 v13, 1472, v14
    s_lshl_b32 s68, s79, 1
    s_add_u32 s68, s68, 156288
    v_add3_u32 v244, v244, v13, s68
    v_mul_u32_u24 v13, 2692, v14
    v_add_u32 v10, v242, v13
    s_lshr_b32 s68, s79, 1
    s_mul_i32 s69, s68, 1344
    s_add_u32 s69, s69, 131072
    v_add_u32 v10, s69, v10
    s_and_b32 s69, s79, 1
    s_lshl_b32 s69, s69, 1
    v_add_u32 v10, s69, v10
    s_lshl_b32 s69, s68, 4
    s_add_u32 s69, s69, 154880
    v_mov_b32 v241, s69
    s_lshl_b32 s69, s79, 3
    s_add_u32 s69, s69, 154880
    v_mov_b32 v11, s69
    s_lshl_b32 s68, s68, 2
    v_add_u32 v240, s68, v25
    v_bfe_u32 v13, v0, 2, 1
    v_lshl_add_u32 v13, v13, 1, v5
    v_mul_u32_u24 v13, 1344, v13
    v_lshl_add_u32 v243, v3, 4, v13
    s_mul_i32 s68, s79, 640
    s_add_u32 s68, s68, 131072
    v_add_u32 v243, s68, v243
    v_cmp_eq_u32 s[62:63], 1, v5
    v_mov_b32 v248, 0
    v_mov_b32 v249, 0
    v_mov_b32 v250, 0
    v_mov_b32 v251, 0
    s_waitcnt vmcnt(0)
    v_xor_b32 v130, s36, v130
    v_xor_b32 v131, s71, v131
    v_xor_b32 v134, s36, v134
    v_xor_b32 v135, s71, v135
    v_xor_b32 v138, s36, v138
    v_xor_b32 v139, s71, v139
    v_xor_b32 v142, s36, v142
    v_xor_b32 v143, s71, v143
    v_or3_b32 v29, v130, v131, v134
    v_or3_b32 v29, v29, v135, v138
    v_or3_b32 v29, v29, v139, v142
    v_or_b32 v29, v29, v143
    s_add_u32 s76, s76, 1
    v_cmp_ne_u32 vcc, 0, v29
    s_cbranch_vccz L_stout
    s_mov_b64 s[60:61], vcc
L_w24:
    ds_read_b32 v27, v25 offset:32
    s_waitcnt lgkmcnt(0)
    v_readfirstlane_b32 s68, v27
    s_nop 0
    s_cmp_lt_u32 s68, 4
    s_cbranch_scc1 L_w24
    s_mov_b64 exec, s[60:61]
L_stloop:
    buffer_load_dwordx4 v[128:131], v9, s[40:43], s74 offen offset:0 sc1
    buffer_load_dwordx4 v[132:135], v9, s[40:43], s74 offen offset:16 sc1
    buffer_load_dwordx4 v[136:139], v9, s[40:43], s74 offen offset:128 sc1
    buffer_load_dwordx4 v[140:143], v9, s[40:43], s74 offen offset:144 sc1
    s_waitcnt vmcnt(0)
    v_xor_b32 v130, s36, v130
    v_xor_b32 v131, s71, v131
    v_xor_b32 v134, s36, v134
    v_xor_b32 v135, s71, v135
    v_xor_b32 v138, s36, v138
    v_xor_b32 v139, s71, v139
    v_xor_b32 v142, s36, v142
    v_xor_b32 v143, s71, v143
    v_or3_b32 v29, v130, v131, v134
    v_or3_b32 v29, v29, v135, v138
    v_or3_b32 v29, v29, v139, v142
    v_or_b32 v29, v29, v143
    s_add_u32 s76, s76, 1
    v_cmp_ne_u32 vcc, 0, v29
    s_cmp_gt_u32 s76, 200000
    s_cbranch_scc1 L_stout
    s_cbranch_vccz L_stout
    s_mov_b64 exec, vcc
    s_branch L_stloop
L_stout:
    s_mov_b64 exec, -1
    buffer_load_dwordx4 v[96:99], v1, s[40:43], s73 offen offset:0 sc1
    buffer_load_dwordx4 v[100:103], v1, s[40:43], s73 offen offset:1024 sc1
    buffer_load_dwordx4 v[104:107], v1, s[40:43], s73 offen offset:2048 sc1
    buffer_load_dwordx4 v[108:111], v1, s[40:43], s73 offen offset:3072 sc1
    buffer_load_dwordx4 v[112:115], v1, s[40:43], s67 offen offset:0 sc1
    buffer_load_dwordx4 v[116:119], v1, s[40:43], s67 offen offset:1024 sc1
    buffer_load_dwordx4 v[120:123], v1, s[40:43], s67 offen offset:2048 sc1
    buffer_load_dwordx4 v[124:127], v1, s[40:43], s67 offen offset:3072 sc1
    s_mov_b64 exec, 1
    ds_add_u32 v25, v26 offset:56
    s_mov_b64 exec, -1
    v_max3_f32 v12, v128, v132, v136
    v_max_f32 v12, v12, v140
    s_nop 1
    v_max_f32_dpp v12, v12, v12 row_ror:8 row_mask:0xf bank_mask:0xf
    v_mov_b32 v13, v12
    s_nop 1
    v_permlane32_swap_b32 v12, v13
    v_max_f32 v12, v12, v13
    v_mov_b32 v13, v12
    s_nop 1
    v_permlane16_swap_b32 v12, v13
    v_max_f32 v12, v12, v13
    v_sub_f32 v128, v128, v12
    v_sub_f32 v132, v132, v12
    v_sub_f32 v136, v136, v12
    v_sub_f32 v140, v140, v12
    v_exp_f32 v128, v128
    v_exp_f32 v132, v132
    v_exp_f32 v136, v136
    v_exp_f32 v140, v140
    v_mul_f32 v13, v128, v129
    v_fmac_f32 v13, v132, v133
    v_fmac_f32 v13, v136, v137
    v_fmac_f32 v13, v140, v141
    s_nop 1
    v_add_f32_dpp v13, v13, v13 row_ror:8 row_mask:0xf bank_mask:0xf
    v_mov_b32 v14, v13
    s_nop 1
    v_permlane32_swap_b32 v13, v14
    v_add_f32 v13, v13, v14
    v_mov_b32 v14, v13
    s_nop 1
    v_permlane16_swap_b32 v13, v14
    v_add_f32 v13, v13, v14
    ds_write_b64 v11, v[12:13]
    s_mov_b64 exec, 1
    ds_add_u32 v240, v26 offset:60
    s_mov_b64 exec, -1
L_scw:
    ds_read_b32 v27, v240 offset:60
    ds_read_b128 v[144:147], v241
    s_waitcnt lgkmcnt(0)
    v_readfirstlane_b32 s68, v27
    s_nop 0
    s_cmp_lt_u32 s68, 2
    s_cbranch_scc1 L_scw
    v_max_f32 v14, v144, v146
    v_sub_f32 v144, v144, v14
    v_sub_f32 v146, v146, v14
    v_sub_f32 v12, v12, v14
    v_exp_f32 v144, v144
    v_exp_f32 v146, v146
    v_exp_f32 v12, v12
    v_mul_f32 v14, v144, v145
    v_fmac_f32 v14, v146, v147
    v_rcp_f32 v14, v14
    s_nop 0
    v_mul_f32 v12, v12, v14
    v_mul_f32 v128, v128, v12
    v_mul_f32 v132, v132, v12
    v_mul_f32 v136, v136, v12
    v_mul_f32 v140, v140, v12
    v_cvt_pk_bf16_f32 v144, v128, v132
    v_cvt_pk_bf16_f32 v145, v136, v140
    s_nop 0
    v_mov_b32_dpp v146, v144 row_ror:8 row_mask:0xf bank_mask:0xf
    v_mov_b32_dpp v147, v145 row_ror:8 row_mask:0xf bank_mask:0xf
    v_cndmask_b32 v148, v144, v146, s[62:63]
    v_cndmask_b32 v149, v145, v147, s[62:63]
    v_cndmask_b32 v150, v146, v144, s[62:63]
    v_cndmask_b32 v151, v147, v145, s[62:63]
    v_and_b32 v160, v148, v20
    v_and_b32 v161, v148, v21
    v_and_b32 v162, v148, v22
    v_and_b32 v163, v148, v23
    v_and_b32 v164, v149, v20
    v_and_b32 v165, v149, v21
    v_and_b32 v166, v149, v22
    v_and_b32 v167, v149, v23
    v_and_b32 v168, v150, v20
    v_and_b32 v169, v150, v21
    v_and_b32 v170, v150, v22
    v_and_b32 v171, v150, v23
    v_and_b32 v172, v151, v20
    v_and_b32 v173, v151, v21
    v_and_b32 v174, v151, v22
    v_and_b32 v175, v151, v23
L_s3loop:
    s_add_u32 s77, s77, 1
    v_mov_b32 v152, 0
    v_mov_b32 v153, 0
    v_mov_b32 v154, 0
    v_mov_b32 v155, 0
    s_waitcnt vmcnt(4)
    v_xor_b32 v96, v96, v16
    v_xor_b32 v97, v97, v17
    v_xor_b32 v98, v98, v18
    v_xor_b32 v99, v99, v19
    v_xor_b32 v100, v100, v16
    v_xor_b32 v101, v101, v17
    v_xor_b32 v102, v102, v18
    v_xor_b32 v103, v103, v19
    v_xor_b32 v104, v104, v16
    v_xor_b32 v105, v105, v17
    v_xor_b32 v106, v106, v18
    v_xor_b32 v107, v107, v19
    v_xor_b32 v108, v108, v16
    v_xor_b32 v109, v109, v17
    v_xor_b32 v110, v110, v18
    v_xor_b32 v111, v111, v19
    v_smfmac_f32_16x16x64_bf16 v[152:155], v[160:163], v[96:103], v24
    s_nop 0
    v_smfmac_f32_16x16x64_bf16 v[152:155], v[164:167], v[104:111], v24
    v_or3_b32 v28, v96, v97, v98
    v_or3_b32 v28, v28, v99, v100
    v_or3_b32 v28, v28, v101, v102
    v_or3_b32 v28, v28, v103, v104
    v_or3_b32 v28, v28, v105, v106
    v_or3_b32 v28, v28, v107, v108
    v_or3_b32 v28, v28, v109, v110
    v_or_b32 v28, v28, v111
    s_waitcnt vmcnt(2)
    v_xor_b32 v112, v112, v16
    v_xor_b32 v113, v113, v17
    v_xor_b32 v114, v114, v18
    v_xor_b32 v115, v115, v19
    v_xor_b32 v116, v116, v16
    v_xor_b32 v117, v117, v17
    v_xor_b32 v118, v118, v18
    v_xor_b32 v119, v119, v19
    s_waitcnt vmcnt(0)
    v_xor_b32 v120, v120, v16
    v_xor_b32 v121, v121, v17
    v_xor_b32 v122, v122, v18
    v_xor_b32 v123, v123, v19
    v_xor_b32 v124, v124, v16
    v_xor_b32 v125, v125, v17
    v_xor_b32 v126, v126, v18
    v_xor_b32 v127, v127, v19
    v_smfmac_f32_16x16x64_bf16 v[152:155], v[168:171], v[112:119], v24
    s_nop 0
    v_smfmac_f32_16x16x64_bf16 v[152:155], v[172:175], v[120:127], v24
    v_or3_b32 v14, v112, v113, v114
    v_or3_b32 v14, v14, v115, v116
    v_or3_b32 v14, v14, v117, v118
    v_or3_b32 v14, v14, v119, v120
    v_or3_b32 v14, v14, v121, v122
    v_or3_b32 v14, v14, v123, v124
    v_or3_b32 v14, v14, v125, v126
    v_or_b32 v14, v14, v127
    v_cvt_pk_bf16_f32 v12, v152, v153
    v_cvt_pk_bf16_f32 v13, v154, v155
    ds_write_b16 v10, v12
    ds_write_b16_d16_hi v10, v12 offset:8
    ds_write_b16 v10, v13 offset:16
    ds_write_b16_d16_hi v10, v13 offset:24
    v_or_b32 v28, v28, v14
    v_and_b32 v28, s72, v28
    v_cmp_ne_u32 vcc, 0, v28
    s_cmp_gt_u32 s77, 200000
    s_cbranch_scc1 L_s3out
    s_cbranch_vccz L_s3out
    buffer_load_dwordx4 v[96:99], v1, s[40:43], s73 offen offset:0 sc1
    buffer_load_dwordx4 v[100:103], v1, s[40:43], s73 offen offset:1024 sc1
    buffer_load_dwordx4 v[104:107], v1, s[40:43], s73 offen offset:2048 sc1
    buffer_load_dwordx4 v[108:111], v1, s[40:43], s73 offen offset:3072 sc1
    buffer_load_dwordx4 v[112:115], v1, s[40:43], s67 offen offset:0 sc1
    buffer_load_dwordx4 v[116:119], v1, s[40:43], s67 offen offset:1024 sc1
    buffer_load_dwordx4 v[120:123], v1, s[40:43], s67 offen offset:2048 sc1
    buffer_load_dwordx4 v[124:127], v1, s[40:43], s67 offen offset:3072 sc1
    s_branch L_s3loop
L_s3out:
    s_mov_b64 exec, 1
    ds_add_u32 v25, v26 offset:48
    s_mov_b64 exec, -1
    s_cmp_lt_u32 s79, 2
    s_cbranch_scc1 L_wu
    s_branch L_b3
L_wu:
L_w25:
    ds_read_b32 v27, v25 offset:48
    ds_read_b128 v[96:99], v243 offset:0
    ds_read_b128 v[100:103], v243 offset:80
    ds_read_b128 v[104:107], v243 offset:160
    ds_read_b128 v[108:111], v243 offset:240
    ds_read_b128 v[112:115], v243 offset:320
    ds_read_b128 v[116:119], v243 offset:400
    ds_read_b128 v[120:123], v243 offset:480
    ds_read_b128 v[124:127], v243 offset:560
    s_waitcnt lgkmcnt(0)
    v_readfirstlane_b32 s68, v27
    s_nop 0
    s_cmp_lt_u32 s68, 4
    s_cbranch_scc1 L_w25
    v_smfmac_f32_16x16x64_bf16 v[248:251], v[96:99], v[176:183], v24
    v_smfmac_f32_16x16x64_bf16 v[248:251], v[100:103], v[184:191], v24
    v_smfmac_f32_16x16x64_bf16 v[248:251], v[104:107], v[192:199], v24
    v_smfmac_f32_16x16x64_bf16 v[248:251], v[108:111], v[200:207], v24
    v_smfmac_f32_16x16x64_bf16 v[248:251], v[112:115], v[208:215], v24
    v_smfmac_f32_16x16x64_bf16 v[248:251], v[116:119], v[216:223], v24
    v_smfmac_f32_16x16x64_bf16 v[248:251], v[120:123], v[224:231], v24
    v_smfmac_f32_16x16x64_bf16 v[248:251], v[124:127], v[232:239], v24
    s_nop 7
    v_cvt_pk_bf16_f32 v12, v248, v249
    v_cvt_pk_bf16_f32 v13, v250, v251
    ds_write_b16 v244, v12 offset:0
    ds_write_b16_d16_hi v244, v12 offset:8
    ds_write_b16 v244, v13 offset:16
    ds_write_b16_d16_hi v244, v13 offset:24
    ds_write_b16 v244, v12 offset:2948
    ds_write_b16_d16_hi v244, v12 offset:2956
    ds_write_b16 v244, v13 offset:2964
    ds_write_b16_d16_hi v244, v13 offset:2972
L_b3:
    s_waitcnt lgkmcnt(0)
    s_barrier
L_end:
    s_endpgm
L_codeend:
.section .rodata,"a"
.p2align 6
.amdhsa_kernel parallel_sum__compressed_kv_cla__glu_gated_bilinear__decode_kernel
  .amdhsa_next_free_vgpr 256
  .amdhsa_next_free_sgpr 102
  .amdhsa_accum_offset 256
  .amdhsa_group_segment_fixed_size 0
  .amdhsa_kernarg_size 104
  .amdhsa_user_sgpr_count 2
  .amdhsa_user_sgpr_kernarg_segment_ptr 1
  .amdhsa_system_sgpr_workgroup_id_x 1
  .amdhsa_float_denorm_mode_32 3
.end_amdhsa_kernel
```
